```python
import torch

def _softmax(x, axis=-1):
    return torch.softmax(x, dim=axis)
def _gelu(x):
    return torch.nn.functional.gelu(x, approximate="tanh")
def _silu(x):
    return torch.nn.functional.silu(x)
def _sigmoid(x):
    return torch.sigmoid(x)
def _layernorm(x, axis=-1, eps=1e-5):
    m = x.mean(dim=axis, keepdim=True)
    v = x.var(dim=axis, keepdim=True, unbiased=False)
    return (x - m) / torch.sqrt(v + eps)
def _scatter_add(tgt, idx, src, axis=0):
    return tgt.clone().index_add_(axis, idx, src)
def _segment_sum(src, seg, n):
    out = torch.zeros((n,) + src.shape[1:], dtype=src.dtype)
    return out.index_add_(0, seg, src)
def _pad(x, pw):
    flat = tuple(v for pair in reversed(pw) for v in pair)
    return torch.nn.functional.pad(x, flat)

kernel_name = 'standalone__glu_gated_geglu__prompt'

def setup_inputs():

    _w = (lambda a: (lambda t: t.to(torch.bfloat16) if t.is_floating_point() else t)(torch.as_tensor(a)))
    B, S, Dm, Df = 1, 2048, 640, 1536
    return {
        "x": _w((lambda *s: torch.randn(*s, dtype=torch.bfloat16) * 0.05)(B, S, Dm)),
        "w_gate": _w((lambda *s: torch.randn(*s, dtype=torch.bfloat16) * 0.05)(Dm, Df) * (Dm ** -0.5)),
        "w_up": _w((lambda *s: torch.randn(*s, dtype=torch.bfloat16) * 0.05)(Dm, Df) * (Dm ** -0.5)),
        "w_down": _w((lambda *s: torch.randn(*s, dtype=torch.bfloat16) * 0.05)(Df, Dm) * (Df ** -0.5)),
    }

def reference(x, w_gate, w_up, w_down):
    g = torch.einsum("bsd,df->bsf", x, w_gate)
    u = torch.einsum("bsd,df->bsf", x, w_up)
    h = _gelu(g) * u
    return torch.einsum("bsf,fd->bsd", h, w_down)
```

```asm
; @launch grid=(256,1,1) block=(512,1,1) lds=163840
.amdgcn_target "amdgcn-amd-amdhsa--gfx950"
.text
.p2align 12
.globl standalone__glu_gated_geglu__prompt_kernel
.p2align 8
.type standalone__glu_gated_geglu__prompt_kernel,@function
standalone__glu_gated_geglu__prompt_kernel:
    s_cmp_ge_u32 s2, 256
    s_cbranch_scc1 F_end
    s_load_dwordx8 s[4:11], s[0:1], 0
    s_load_dwordx4 s[12:15], s[0:1], 32
    s_load_dwordx2 s[16:17], s[0:1], 48
    v_lshrrev_b32 v1, 6, v0
    v_and_b32 v2, 63, v0
    v_readfirstlane_b32 s18, v1
    s_and_b32 s52, s2, 7
    s_lshr_b32 s53, s2, 3
    s_cmp_ge_u32 s53, 30
    s_cbranch_scc1 F_helper
    s_cmp_ge_u32 s18, 4
    s_cbranch_scc1 F_loader
    s_or_b32 s64, s2, s18
    s_cmp_lg_u32 s64, 0
    s_cbranch_scc1 F_compute
    s_memrealtime s[64:65]
    v_mov_b32 v8, 0
    s_waitcnt lgkmcnt(0)
    s_mov_b32 s44, s14
    s_and_b32 s45, s15, 0xffff
    s_mov_b32 s46, 256
    s_mov_b32 s47, 0x00020000
    s_lshl_b64 s[64:65], s[64:65], 1
    s_or_b32 s65, s65, 0x40000000
    v_mov_b32 v18, s64
    v_mov_b32 v19, s65
    s_mov_b64 exec, 1
    buffer_store_dwordx2 v[18:19], v8, s[44:47], 0 offen sc1
    s_mov_b64 exec, -1
    s_branch F_compute
F_loader:
    s_sub_u32 s19, s18, 4
    s_mul_i32 s56, s53, 10923
    s_lshr_b32 s56, s56, 16
    s_mul_i32 s58, s56, 6
    s_sub_u32 s58, s53, s58
    s_lshr_b32 s54, s52, 2
    s_mul_i32 s54, s54, 5
    s_add_u32 s54, s54, s56
    s_and_b32 s55, s52, 3
    s_mul_i32 s55, s55, 6
    s_add_u32 s55, s55, s58
    s_mul_i32 s51, s54, 13
    s_min_u32 s51, s51, 116
    s_mul_i32 s56, s56, 2
    s_mul_i32 s58, s58, 0
    s_add_u32 s56, s56, s58
    s_mul_i32 s57, s56, 13108
    s_lshr_b32 s57, s57, 16
    s_mul_i32 s57, s57, 5
    s_sub_u32 s56, s56, s57
    s_mul_i32 s56, s56, 8
    s_lshr_b32 s57, s52, 2
    s_mul_i32 s57, s57, 4
    s_add_u32 s56, s56, s57
    s_and_b32 s57, s52, 3
    s_mul_i32 s57, s57, 10
    s_add_u32 s56, s56, s57
    s_lshr_b32 s56, s56, 2
    s_mul_i32 s57, s56, 6554
    s_lshr_b32 s57, s57, 16
    s_mul_i32 s57, s57, 10
    s_sub_u32 s56, s56, s57
    v_lshrrev_b32 v3, 3, v2
    v_and_b32 v4, 7, v2
    v_lshrrev_b32 v5, 4, v2
    s_lshl_b32 s57, s19, 1
    v_add_u32 v6, s57, v5
    v_and_b32 v6, 7, v6
    v_xor_b32 v6, v4, v6
    v_lshlrev_b32 v6, 4, v6
    s_lshl_b32 s57, s51, 4
    s_mul_i32 s58, s19, 52
    s_add_u32 s57, s57, s58
    v_add_u32 v7, s57, v3
    v_mul_u32_u24 v7, 1280, v7
    v_add_u32 v10, v7, v6
    v_xor_b32 v6, 64, v6
    v_add_u32 v11, v7, v6
    v_add_u32 v11, 9216, v11
    v_add_u32 v12, 18432, v10
    v_add_u32 v13, 18432, v11
    v_add_u32 v14, 40960, v10
    v_add_u32 v15, 40960, v11
    v_add_u32 v16, 40960, v12
    s_lshl_b32 s57, s19, 4
    v_add_u32 v7, s57, v3
    v_mul_u32_u24 v7, 3072, v7
    s_lshl_b32 s58, s55, 7
    v_add_u32 v7, s58, v7
    v_and_b32 v5, 1, v5
    v_lshlrev_b32 v5, 1, v5
    v_xor_b32 v5, v4, v5
    v_lshl_add_u32 v17, v5, 4, v7
    v_xor_b32 v5, 4, v5
    v_lshl_add_u32 v18, v5, 4, v7
    v_add_u32 v18, 23552, v18
    s_mul_i32 s63, s19, 6656
    s_lshl_b32 s64, s19, 11
    s_add_u32 s64, s64, 26624
    s_mov_b32 s62, 120832
    s_lshl_b32 s65, s56, 7
    s_mul_i32 s66, s56, 196608
    s_add_u32 m0, s62, s63
    s_add_u32 s56, s56, 1
    s_waitcnt lgkmcnt(0)
    s_mov_b32 s20, s4
    s_and_b32 s21, s5, 0xffff
    s_mov_b32 s22, 2621440
    s_mov_b32 s23, 0x00020000
    buffer_load_dwordx4 v10, s[20:23], s65 offen offset:0  lds
    buffer_load_dwordx4 v11, s[20:23], s65 offen offset:1024  lds
    buffer_load_dwordx4 v12, s[20:23], s65 offen offset:2048  lds
    buffer_load_dwordx4 v13, s[20:23], s65 offen offset:3072  lds
    s_add_u32 m0, m0, 4096
    s_cmp_eq_u32 s56, 10
    s_cselect_b32 s56, 0, s56
    buffer_load_dwordx4 v14, s[20:23], s65 offen offset:0  lds
    buffer_load_dwordx4 v15, s[20:23], s65 offen offset:1024  lds
    s_mov_b32 exec_hi, 0
    buffer_load_dwordx4 v16, s[20:23], s65 offen offset:2048  lds
    s_mov_b32 exec_hi, -1
    s_mov_b32 s24, s6
    s_and_b32 s25, s7, 0xffff
    s_mov_b32 s26, 1966080
    s_mov_b32 s27, 0x00020000
    s_add_u32 m0, s62, s64
    s_add_u32 s62, s62, 43008
    buffer_load_dwordx4 v17, s[24:27], s66 offen offset:0  lds
    buffer_load_dwordx4 v18, s[24:27], s66 offen offset:1024  lds
    s_mov_b32 s28, s8
    s_and_b32 s29, s9, 0xffff
    s_mov_b32 s30, 1966080
    s_mov_b32 s31, 0x00020000
    s_add_u32 m0, m0, 8192
    s_cmp_eq_u32 s62, 163840
    s_cselect_b32 s62, 34816, s62
    buffer_load_dwordx4 v17, s[28:31], s66 offen offset:0  lds
    buffer_load_dwordx4 v18, s[28:31], s66 offen offset:1024  lds
    s_lshl_b32 s65, s56, 7
    s_mul_i32 s66, s56, 196608
    s_add_u32 m0, s62, s63
    s_add_u32 s56, s56, 1
    buffer_load_dwordx4 v10, s[20:23], s65 offen offset:0  lds
    buffer_load_dwordx4 v11, s[20:23], s65 offen offset:1024  lds
    buffer_load_dwordx4 v12, s[20:23], s65 offen offset:2048  lds
    buffer_load_dwordx4 v13, s[20:23], s65 offen offset:3072  lds
    s_add_u32 m0, m0, 4096
    s_cmp_eq_u32 s56, 10
    s_cselect_b32 s56, 0, s56
    buffer_load_dwordx4 v14, s[20:23], s65 offen offset:0  lds
    buffer_load_dwordx4 v15, s[20:23], s65 offen offset:1024  lds
    s_mov_b32 exec_hi, 0
    buffer_load_dwordx4 v16, s[20:23], s65 offen offset:2048  lds
    s_mov_b32 exec_hi, -1
    s_add_u32 m0, s62, s64
    s_add_u32 s62, s62, 43008
    buffer_load_dwordx4 v17, s[24:27], s66 offen offset:0  lds
    buffer_load_dwordx4 v18, s[24:27], s66 offen offset:1024  lds
    s_add_u32 m0, m0, 8192
    s_cmp_eq_u32 s62, 163840
    s_cselect_b32 s62, 34816, s62
    buffer_load_dwordx4 v17, s[28:31], s66 offen offset:0  lds
    buffer_load_dwordx4 v18, s[28:31], s66 offen offset:1024  lds
    s_mov_b32 s32, s10
    s_and_b32 s33, s11, 0xffff
    s_mov_b32 s34, 1966080
    s_mov_b32 s35, 0x00020000
    s_mov_b32 s40, s16
    s_and_b32 s41, s17, 0xffff
    s_mov_b32 s42, 268435456
    s_mov_b32 s43, 0x00020000
    s_mov_b32 s44, s14
    s_and_b32 s45, s15, 0xffff
    s_mov_b32 s46, 256
    s_mov_b32 s47, 0x00020000
    s_lshr_b32 s57, s53, 2
    s_and_b32 s58, s53, 3
    s_lshr_b32 s59, s52, 2
    s_lshl_b32 s59, s59, 1
    s_and_b32 s60, s52, 1
    s_add_u32 s59, s59, s60
    s_lshl_b32 s59, s59, 3
    s_add_u32 s59, s59, s57
    s_bfe_u32 s60, s52, 0x10001
    s_lshl_b32 s60, s60, 2
    s_add_u32 s60, s60, s58
    s_mul_i32 s57, s57, 3
    s_mul_i32 s58, s58, 0
    s_add_u32 s61, s57, s58
    s_lshr_b32 s61, s61, 2
    s_mul_i32 s57, s61, 10923
    s_lshr_b32 s57, s57, 16
    s_mul_i32 s57, s57, 6
    s_sub_u32 s61, s61, s57
    v_and_b32 v5, 15, v2
    s_mov_b32 s57, 0
    v_mov_b32 v8, 0
    v_lshl_add_u32 v29, v5, 7, s57
    v_lshrrev_b32 v5, 3, v2
    v_mul_u32_u24 v5, 1280, v5
    v_lshrrev_b32 v6, 4, v2
    v_lshlrev_b32 v6, 1, v6
    v_and_b32 v7, 7, v2
    v_xor_b32 v6, v6, v7
    v_lshl_add_u32 v5, v6, 4, v5
    s_lshl_b32 s57, s60, 7
    v_add_u32 v20, s57, v5
    v_add_u32 v21, 9216, v20
    v_add_u32 v22, 18432, v20
    v_add_u32 v23, 27648, v20
    s_mul_i32 s57, s60, 49152
    s_add_u32 s57, s57, 1048576
    v_lshlrev_b32 v5, 4, v2
    v_add_u32 v24, s57, v5
    s_mul_i32 s71, s19, 5120
    v_add_u32 v25, s71, v5
    v_add_u32 v26, 40960, v25
    s_lshl_b32 s65, s61, 2
    s_add_u32 s65, s65, s19
    s_mul_i32 s78, s65, 40960
    s_lshl_b32 s84, s65, 10
    s_add_u32 s61, s61, 1
    s_cmp_eq_u32 s61, 6
    s_cselect_b32 s61, 0, s61
    s_lshl_b32 s65, s61, 2
    s_add_u32 s65, s65, s19
    s_mul_i32 s79, s65, 40960
    s_lshl_b32 s85, s65, 10
    s_add_u32 s61, s61, 1
    s_cmp_eq_u32 s61, 6
    s_cselect_b32 s61, 0, s61
    s_lshl_b32 s65, s61, 2
    s_add_u32 s65, s65, s19
    s_mul_i32 s80, s65, 40960
    s_lshl_b32 s86, s65, 10
    s_add_u32 s61, s61, 1
    s_cmp_eq_u32 s61, 6
    s_cselect_b32 s61, 0, s61
    s_lshl_b32 s65, s61, 2
    s_add_u32 s65, s65, s19
    s_mul_i32 s81, s65, 40960
    s_lshl_b32 s87, s65, 10
    s_add_u32 s61, s61, 1
    s_cmp_eq_u32 s61, 6
    s_cselect_b32 s61, 0, s61
    s_lshl_b32 s65, s61, 2
    s_add_u32 s65, s65, s19
    s_mul_i32 s82, s65, 40960
    s_lshl_b32 s88, s65, 10
    s_add_u32 s61, s61, 1
    s_cmp_eq_u32 s61, 6
    s_cselect_b32 s61, 0, s61
    s_lshl_b32 s65, s61, 2
    s_add_u32 s65, s65, s19
    s_mul_i32 s83, s65, 40960
    s_lshl_b32 s89, s65, 10
    s_add_u32 s61, s61, 1
    s_cmp_eq_u32 s61, 6
    s_cselect_b32 s61, 0, s61
    s_waitcnt vmcnt(11)
    s_barrier
    s_cmp_lg_u32 s19, 0
    s_cbranch_scc1 F_Ln0
    buffer_load_dwordx2 v[30:31], v8, s[44:47], 0 offen sc1
F_Ln0:
    s_lshl_b32 s65, s56, 7
    s_mul_i32 s66, s56, 196608
    s_add_u32 m0, s62, s63
    s_add_u32 s56, s56, 1
    buffer_load_dwordx4 v10, s[20:23], s65 offen offset:0  lds
    buffer_load_dwordx4 v11, s[20:23], s65 offen offset:1024  lds
    buffer_load_dwordx4 v12, s[20:23], s65 offen offset:2048  lds
    buffer_load_dwordx4 v13, s[20:23], s65 offen offset:3072  lds
    s_add_u32 m0, m0, 4096
    s_cmp_eq_u32 s56, 10
    s_cselect_b32 s56, 0, s56
    buffer_load_dwordx4 v14, s[20:23], s65 offen offset:0  lds
    buffer_load_dwordx4 v15, s[20:23], s65 offen offset:1024  lds
    s_mov_b32 exec_hi, 0
    buffer_load_dwordx4 v16, s[20:23], s65 offen offset:2048  lds
    s_mov_b32 exec_hi, -1
    s_add_u32 m0, s62, s64
    s_add_u32 s62, s62, 43008
    buffer_load_dwordx4 v17, s[24:27], s66 offen offset:0  lds
    buffer_load_dwordx4 v18, s[24:27], s66 offen offset:1024  lds
    s_add_u32 m0, m0, 8192
    s_cmp_eq_u32 s62, 163840
    s_cselect_b32 s62, 34816, s62
    buffer_load_dwordx4 v17, s[28:31], s66 offen offset:0  lds
    buffer_load_dwordx4 v18, s[28:31], s66 offen offset:1024  lds
    s_waitcnt vmcnt(11)
    s_barrier
    s_cmp_lg_u32 s19, 0
    s_cbranch_scc1 F_Ln1
    s_mov_b32 s70, 0
F_Lnonce:
    v_cmp_ne_u64 vcc, 0, v[30:31]
    s_add_u32 s70, s70, 1
    s_nop 3
    s_cbranch_vccnz F_Lnonce_ok
    s_cmp_gt_u32 s70, 262144
    s_cbranch_scc1 F_Lnonce_ok
    s_sleep 4
    buffer_load_dwordx2 v[30:31], v8, s[44:47], 0 offen sc1
    s_waitcnt vmcnt(0)
    s_branch F_Lnonce
F_Lnonce_ok:
    v_readfirstlane_b32 s94, v30
    s_nop 3
    s_mul_i32 s94, s94, 0x9e3779b1
    s_mul_hi_u32 s94, s94, 31
    s_add_u32 s94, s94, 1
    s_lshl_b32 s94, s94, 23
F_Ln1:
    s_lshl_b32 s65, s56, 7
    s_mul_i32 s66, s56, 196608
    s_add_u32 m0, s62, s63
    s_add_u32 s56, s56, 1
    buffer_load_dwordx4 v10, s[20:23], s65 offen offset:0  lds
    buffer_load_dwordx4 v11, s[20:23], s65 offen offset:1024  lds
    buffer_load_dwordx4 v12, s[20:23], s65 offen offset:2048  lds
    buffer_load_dwordx4 v13, s[20:23], s65 offen offset:3072  lds
    s_add_u32 m0, m0, 4096
    s_cmp_eq_u32 s56, 10
    s_cselect_b32 s56, 0, s56
    buffer_load_dwordx4 v14, s[20:23], s65 offen offset:0  lds
    buffer_load_dwordx4 v15, s[20:23], s65 offen offset:1024  lds
    s_mov_b32 exec_hi, 0
    buffer_load_dwordx4 v16, s[20:23], s65 offen offset:2048  lds
    s_mov_b32 exec_hi, -1
    s_add_u32 m0, s62, s64
    s_add_u32 s62, s62, 43008
    buffer_load_dwordx4 v17, s[24:27], s66 offen offset:0  lds
    buffer_load_dwordx4 v18, s[24:27], s66 offen offset:1024  lds
    s_add_u32 m0, m0, 8192
    s_cmp_eq_u32 s62, 163840
    s_cselect_b32 s62, 34816, s62
    buffer_load_dwordx4 v17, s[28:31], s66 offen offset:0  lds
    buffer_load_dwordx4 v18, s[28:31], s66 offen offset:1024  lds
    s_waitcnt vmcnt(11)
    s_barrier
    s_lshl_b32 s65, s56, 7
    s_mul_i32 s66, s56, 196608
    s_add_u32 m0, s62, s63
    s_add_u32 s56, s56, 1
    buffer_load_dwordx4 v10, s[20:23], s65 offen offset:0  lds
    buffer_load_dwordx4 v11, s[20:23], s65 offen offset:1024  lds
    buffer_load_dwordx4 v12, s[20:23], s65 offen offset:2048  lds
    buffer_load_dwordx4 v13, s[20:23], s65 offen offset:3072  lds
    s_add_u32 m0, m0, 4096
    s_cmp_eq_u32 s56, 10
    s_cselect_b32 s56, 0, s56
    buffer_load_dwordx4 v14, s[20:23], s65 offen offset:0  lds
    buffer_load_dwordx4 v15, s[20:23], s65 offen offset:1024  lds
    s_mov_b32 exec_hi, 0
    buffer_load_dwordx4 v16, s[20:23], s65 offen offset:2048  lds
    s_mov_b32 exec_hi, -1
    s_add_u32 m0, s62, s64
    s_add_u32 s62, s62, 43008
    buffer_load_dwordx4 v17, s[24:27], s66 offen offset:0  lds
    buffer_load_dwordx4 v18, s[24:27], s66 offen offset:1024  lds
    s_add_u32 m0, m0, 8192
    s_cmp_eq_u32 s62, 163840
    s_cselect_b32 s62, 34816, s62
    buffer_load_dwordx4 v17, s[28:31], s66 offen offset:0  lds
    buffer_load_dwordx4 v18, s[28:31], s66 offen offset:1024  lds
    s_waitcnt vmcnt(11)
    s_barrier
    s_lshl_b32 s65, s56, 7
    s_mul_i32 s66, s56, 196608
    s_add_u32 m0, s62, s63
    s_add_u32 s56, s56, 1
    buffer_load_dwordx4 v10, s[20:23], s65 offen offset:0  lds
    buffer_load_dwordx4 v11, s[20:23], s65 offen offset:1024  lds
    buffer_load_dwordx4 v12, s[20:23], s65 offen offset:2048  lds
    buffer_load_dwordx4 v13, s[20:23], s65 offen offset:3072  lds
    s_add_u32 m0, m0, 4096
    s_cmp_eq_u32 s56, 10
    s_cselect_b32 s56, 0, s56
    buffer_load_dwordx4 v14, s[20:23], s65 offen offset:0  lds
    buffer_load_dwordx4 v15, s[20:23], s65 offen offset:1024  lds
    s_mov_b32 exec_hi, 0
    buffer_load_dwordx4 v16, s[20:23], s65 offen offset:2048  lds
    s_mov_b32 exec_hi, -1
    s_add_u32 m0, s62, s64
    s_add_u32 s62, s62, 43008
    buffer_load_dwordx4 v17, s[24:27], s66 offen offset:0  lds
    buffer_load_dwordx4 v18, s[24:27], s66 offen offset:1024  lds
    s_add_u32 m0, m0, 8192
    s_cmp_eq_u32 s62, 163840
    s_cselect_b32 s62, 34816, s62
    buffer_load_dwordx4 v17, s[28:31], s66 offen offset:0  lds
    buffer_load_dwordx4 v18, s[28:31], s66 offen offset:1024  lds
    s_waitcnt vmcnt(11)
    s_barrier
    s_lshl_b32 s65, s56, 7
    s_mul_i32 s66, s56, 196608
    s_add_u32 m0, s62, s63
    s_add_u32 s56, s56, 1
    buffer_load_dwordx4 v10, s[20:23], s65 offen offset:0  lds
    buffer_load_dwordx4 v11, s[20:23], s65 offen offset:1024  lds
    buffer_load_dwordx4 v12, s[20:23], s65 offen offset:2048  lds
    buffer_load_dwordx4 v13, s[20:23], s65 offen offset:3072  lds
    s_add_u32 m0, m0, 4096
    s_cmp_eq_u32 s56, 10
    s_cselect_b32 s56, 0, s56
    buffer_load_dwordx4 v14, s[20:23], s65 offen offset:0  lds
    buffer_load_dwordx4 v15, s[20:23], s65 offen offset:1024  lds
    s_mov_b32 exec_hi, 0
    buffer_load_dwordx4 v16, s[20:23], s65 offen offset:2048  lds
    s_mov_b32 exec_hi, -1
    s_add_u32 m0, s62, s64
    s_add_u32 s62, s62, 43008
    buffer_load_dwordx4 v17, s[24:27], s66 offen offset:0  lds
    buffer_load_dwordx4 v18, s[24:27], s66 offen offset:1024  lds
    s_add_u32 m0, m0, 8192
    s_cmp_eq_u32 s62, 163840
    s_cselect_b32 s62, 34816, s62
    buffer_load_dwordx4 v17, s[28:31], s66 offen offset:0  lds
    buffer_load_dwordx4 v18, s[28:31], s66 offen offset:1024  lds
    s_waitcnt vmcnt(11)
    s_barrier
    s_cmp_lg_u32 s19, 0
    s_cbranch_scc1 F_Lnopoll
    buffer_load_dwordx2 v[40:41], v29, s[40:43], 0 offen sc1
F_Lnopoll:
    s_lshl_b32 s65, s56, 7
    s_mul_i32 s66, s56, 196608
    s_add_u32 m0, s62, s63
    s_add_u32 s56, s56, 1
    buffer_load_dwordx4 v10, s[20:23], s65 offen offset:0  lds
    buffer_load_dwordx4 v11, s[20:23], s65 offen offset:1024  lds
    buffer_load_dwordx4 v12, s[20:23], s65 offen offset:2048  lds
    buffer_load_dwordx4 v13, s[20:23], s65 offen offset:3072  lds
    s_add_u32 m0, m0, 4096
    s_cmp_eq_u32 s56, 10
    s_cselect_b32 s56, 0, s56
    buffer_load_dwordx4 v14, s[20:23], s65 offen offset:0  lds
    buffer_load_dwordx4 v15, s[20:23], s65 offen offset:1024  lds
    s_mov_b32 exec_hi, 0
    buffer_load_dwordx4 v16, s[20:23], s65 offen offset:2048  lds
    s_mov_b32 exec_hi, -1
    s_add_u32 m0, s62, s64
    s_add_u32 s62, s62, 43008
    buffer_load_dwordx4 v17, s[24:27], s66 offen offset:0  lds
    buffer_load_dwordx4 v18, s[24:27], s66 offen offset:1024  lds
    s_add_u32 m0, m0, 8192
    s_cmp_eq_u32 s62, 163840
    s_cselect_b32 s62, 34816, s62
    buffer_load_dwordx4 v17, s[28:31], s66 offen offset:0  lds
    buffer_load_dwordx4 v18, s[28:31], s66 offen offset:1024  lds
    s_waitcnt vmcnt(11)
    s_barrier
    s_cmp_lg_u32 s19, 0
    s_cbranch_scc1 F_Lp1
    s_setprio 3
    s_mov_b32 s70, 0
F_Lpoll:
    v_cmp_ne_u32 s[92:93], v40, v30
    v_and_b32 v40, -2, v40
    v_cmp_ne_u64 vcc, v[40:41], v[30:31]
    s_add_u32 s70, s70, 1
    s_bcnt1_i32_b64 s57, s[92:93]
    s_cmp_gt_u32 s57, 32
    s_cselect_b32 s57, 8192, 0
    s_nop 0
    s_cbranch_vccz F_Lpoll_ok
    s_cmp_gt_u32 s70, 262144
    s_cbranch_scc1 F_Lpoll_ok
    s_sleep 4
    buffer_load_dwordx2 v[40:41], v29, s[40:43], 0 offen sc1
    s_waitcnt vmcnt(0)
    s_branch F_Lpoll
F_Lpoll_ok:
    s_or_b32 s57, s57, s94
    v_mov_b32 v32, s57
    ds_write_b64 v8, v[30:31]
    ds_write_b32 v8, v32 offset:8
    s_setprio 0
F_Lp1:
    s_lshl_b32 s65, s56, 7
    s_mul_i32 s66, s56, 196608
    s_add_u32 m0, s62, s63
    s_add_u32 s56, s56, 1
    buffer_load_dwordx4 v10, s[20:23], s65 offen offset:0  lds
    buffer_load_dwordx4 v11, s[20:23], s65 offen offset:1024  lds
    buffer_load_dwordx4 v12, s[20:23], s65 offen offset:2048  lds
    buffer_load_dwordx4 v13, s[20:23], s65 offen offset:3072  lds
    s_add_u32 m0, m0, 4096
    s_cmp_eq_u32 s56, 10
    s_cselect_b32 s56, 0, s56
    buffer_load_dwordx4 v14, s[20:23], s65 offen offset:0  lds
    buffer_load_dwordx4 v15, s[20:23], s65 offen offset:1024  lds
    s_mov_b32 exec_hi, 0
    buffer_load_dwordx4 v16, s[20:23], s65 offen offset:2048  lds
    s_mov_b32 exec_hi, -1
    s_add_u32 m0, s62, s64
    s_add_u32 s62, s62, 43008
    buffer_load_dwordx4 v17, s[24:27], s66 offen offset:0  lds
    buffer_load_dwordx4 v18, s[24:27], s66 offen offset:1024  lds
    s_add_u32 m0, m0, 8192
    s_cmp_eq_u32 s62, 163840
    s_cselect_b32 s62, 34816, s62
    buffer_load_dwordx4 v17, s[28:31], s66 offen offset:0  lds
    buffer_load_dwordx4 v18, s[28:31], s66 offen offset:1024  lds
    s_waitcnt vmcnt(11) lgkmcnt(0)
    s_barrier
    s_lshl_b32 s65, s56, 7
    s_mul_i32 s66, s56, 196608
    s_add_u32 m0, s62, s63
    s_add_u32 s56, s56, 1
    buffer_load_dwordx4 v10, s[20:23], s65 offen offset:0  lds
    buffer_load_dwordx4 v11, s[20:23], s65 offen offset:1024  lds
    buffer_load_dwordx4 v12, s[20:23], s65 offen offset:2048  lds
    buffer_load_dwordx4 v13, s[20:23], s65 offen offset:3072  lds
    s_add_u32 m0, m0, 4096
    s_cmp_eq_u32 s56, 10
    s_cselect_b32 s56, 0, s56
    buffer_load_dwordx4 v14, s[20:23], s65 offen offset:0  lds
    buffer_load_dwordx4 v15, s[20:23], s65 offen offset:1024  lds
    s_mov_b32 exec_hi, 0
    buffer_load_dwordx4 v16, s[20:23], s65 offen offset:2048  lds
    s_mov_b32 exec_hi, -1
    s_add_u32 m0, s62, s64
    s_add_u32 s62, s62, 43008
    buffer_load_dwordx4 v17, s[24:27], s66 offen offset:0  lds
    buffer_load_dwordx4 v18, s[24:27], s66 offen offset:1024  lds
    s_add_u32 m0, m0, 8192
    s_cmp_eq_u32 s62, 163840
    s_cselect_b32 s62, 34816, s62
    buffer_load_dwordx4 v17, s[28:31], s66 offen offset:0  lds
    buffer_load_dwordx4 v18, s[28:31], s66 offen offset:1024  lds
    s_waitcnt vmcnt(11)
    s_barrier
F_L2:
    s_add_u32 m0, s71, 0
    s_nop 0
    buffer_load_dwordx4 v20, s[32:35], s78 offen offset:0 lds
    buffer_load_dwordx4 v21, s[32:35], s78 offen offset:1024 lds
    buffer_load_dwordx4 v22, s[32:35], s78 offen offset:2048 lds
    buffer_load_dwordx4 v23, s[32:35], s78 offen offset:3072 lds
    s_add_u32 m0, s71, 4096
    s_nop 0
    buffer_load_dwordx4 v24, s[40:43], s84 offen sc1 lds
    s_add_u32 s90, s78, 983040
    s_add_u32 s91, s84, 24576
    s_add_u32 m0, s71, 20480
    s_nop 0
    buffer_load_dwordx4 v20, s[32:35], s90 offen offset:0 lds
    buffer_load_dwordx4 v21, s[32:35], s90 offen offset:1024 lds
    buffer_load_dwordx4 v22, s[32:35], s90 offen offset:2048 lds
    buffer_load_dwordx4 v23, s[32:35], s90 offen offset:3072 lds
    s_add_u32 m0, s71, 24576
    s_nop 0
    buffer_load_dwordx4 v24, s[40:43], s91 offen sc1 lds
    s_waitcnt vmcnt(10)
    s_barrier
    s_add_u32 m0, s71, 40960
    s_nop 0
    buffer_load_dwordx4 v20, s[32:35], s79 offen offset:0 lds
    buffer_load_dwordx4 v21, s[32:35], s79 offen offset:1024 lds
    buffer_load_dwordx4 v22, s[32:35], s79 offen offset:2048 lds
    buffer_load_dwordx4 v23, s[32:35], s79 offen offset:3072 lds
    s_add_u32 m0, s71, 45056
    s_nop 0
    buffer_load_dwordx4 v24, s[40:43], s85 offen sc1 lds
    s_add_u32 s90, s79, 983040
    s_add_u32 s91, s85, 24576
    s_add_u32 m0, s71, 61440
    s_nop 0
pad_S_0:
    s_cbranch_execz S_ret
    buffer_load_dwordx4 v20, s[32:35], s90 offen offset:0 lds
    buffer_load_dwordx4 v21, s[32:35], s90 offen offset:1024 lds
    buffer_load_dwordx4 v22, s[32:35], s90 offen offset:2048 lds
    buffer_load_dwordx4 v23, s[32:35], s90 offen offset:3072 lds
    s_add_u32 m0, s71, 65536
    s_nop 0
    buffer_load_dwordx4 v24, s[40:43], s91 offen sc1 lds
    s_barrier
    s_add_u32 m0, s71, 81920
    s_waitcnt vmcnt(4)
    buffer_load_dwordx4 v20, s[32:35], s80 offen offset:0 lds
    s_waitcnt vmcnt(4)
    buffer_load_dwordx4 v21, s[32:35], s80 offen offset:1024 lds
    s_waitcnt vmcnt(4)
    buffer_load_dwordx4 v22, s[32:35], s80 offen offset:2048 lds
    s_waitcnt vmcnt(4)
    buffer_load_dwordx4 v23, s[32:35], s80 offen offset:3072 lds
    s_add_u32 m0, s71, 86016
    s_waitcnt vmcnt(4)
    buffer_load_dwordx4 v24, s[40:43], s86 offen sc1 lds
    s_add_u32 s90, s80, 983040
    s_add_u32 s91, s86, 24576
    s_add_u32 m0, s71, 102400
    s_waitcnt vmcnt(4)
    buffer_load_dwordx4 v20, s[32:35], s90 offen offset:0 lds
    s_waitcnt vmcnt(4)
    buffer_load_dwordx4 v21, s[32:35], s90 offen offset:1024 lds
    s_waitcnt vmcnt(4)
    buffer_load_dwordx4 v22, s[32:35], s90 offen offset:2048 lds
    s_waitcnt vmcnt(4)
    buffer_load_dwordx4 v23, s[32:35], s90 offen offset:3072 lds
    s_add_u32 m0, s71, 106496
    s_waitcnt vmcnt(4)
    buffer_load_dwordx4 v24, s[40:43], s91 offen sc1 lds
    s_waitcnt vmcnt(3)
    buffer_load_dwordx4 v[64:67], v20, s[32:35], s82 offen offset:0
    s_waitcnt vmcnt(3)
    buffer_load_dwordx4 v[68:71], v21, s[32:35], s82 offen offset:1024
    s_waitcnt vmcnt(3)
    buffer_load_dwordx4 v[72:75], v22, s[32:35], s82 offen offset:2048
    s_waitcnt vmcnt(3)
    buffer_load_dwordx4 v[76:79], v23, s[32:35], s82 offen offset:3072
    s_waitcnt vmcnt(3)
    buffer_load_dwordx4 v[80:83], v24, s[40:43], s88 offen sc1
    s_add_u32 s90, s82, 983040
    s_add_u32 s91, s88, 24576
    s_waitcnt vmcnt(3)
    buffer_load_dwordx4 v[84:87], v20, s[32:35], s90 offen offset:0
    s_waitcnt vmcnt(3)
    buffer_load_dwordx4 v[88:91], v21, s[32:35], s90 offen offset:1024
    s_waitcnt vmcnt(3)
    buffer_load_dwordx4 v[92:95], v22, s[32:35], s90 offen offset:2048
    s_waitcnt vmcnt(3)
    buffer_load_dwordx4 v[96:99], v23, s[32:35], s90 offen offset:3072
    s_waitcnt vmcnt(3)
    buffer_load_dwordx4 v[100:103], v24, s[40:43], s91 offen sc1
    s_waitcnt vmcnt(5)
    buffer_load_dwordx4 v[104:107], v20, s[32:35], s83 offen offset:0
    s_waitcnt vmcnt(5)
    buffer_load_dwordx4 v[108:111], v21, s[32:35], s83 offen offset:1024
    s_waitcnt vmcnt(5)
    buffer_load_dwordx4 v[112:115], v22, s[32:35], s83 offen offset:2048
    s_waitcnt vmcnt(5)
    buffer_load_dwordx4 v[116:119], v23, s[32:35], s83 offen offset:3072
    s_waitcnt vmcnt(5)
    buffer_load_dwordx4 v[120:123], v24, s[40:43], s89 offen sc1
    s_add_u32 s90, s83, 983040
    s_add_u32 s91, s89, 24576
    s_waitcnt vmcnt(5)
    buffer_load_dwordx4 v[124:127], v20, s[32:35], s90 offen offset:0
    s_waitcnt vmcnt(5)
    buffer_load_dwordx4 v[128:131], v21, s[32:35], s90 offen offset:1024
    s_waitcnt vmcnt(5)
    buffer_load_dwordx4 v[132:135], v22, s[32:35], s90 offen offset:2048
    s_waitcnt vmcnt(5)
    buffer_load_dwordx4 v[136:139], v23, s[32:35], s90 offen offset:3072
    s_waitcnt vmcnt(5)
    buffer_load_dwordx4 v[140:143], v24, s[40:43], s91 offen sc1
    s_waitcnt vmcnt(20)
    s_barrier
    s_add_u32 m0, s71, 122880
    s_nop 0
    buffer_load_dwordx4 v20, s[32:35], s81 offen offset:0 lds
    buffer_load_dwordx4 v21, s[32:35], s81 offen offset:1024 lds
    buffer_load_dwordx4 v22, s[32:35], s81 offen offset:2048 lds
    buffer_load_dwordx4 v23, s[32:35], s81 offen offset:3072 lds
    s_add_u32 m0, s71, 126976
    s_nop 0
    buffer_load_dwordx4 v24, s[40:43], s87 offen sc1 lds
    s_add_u32 s90, s81, 983040
    s_add_u32 s91, s87, 24576
    s_add_u32 m0, s71, 143360
    s_nop 0
    buffer_load_dwordx4 v20, s[32:35], s90 offen offset:0 lds
    buffer_load_dwordx4 v21, s[32:35], s90 offen offset:1024 lds
    buffer_load_dwordx4 v22, s[32:35], s90 offen offset:2048 lds
    buffer_load_dwordx4 v23, s[32:35], s90 offen offset:3072 lds
    s_add_u32 m0, s71, 147456
    s_nop 0
    buffer_load_dwordx4 v24, s[40:43], s91 offen sc1 lds
    s_barrier
    s_waitcnt vmcnt(20)
    ds_write_b128 v25, v[64:67] offset:0
    ds_write_b128 v25, v[68:71] offset:1024
    ds_write_b128 v25, v[72:75] offset:2048
    ds_write_b128 v25, v[76:79] offset:3072
    ds_write_b128 v25, v[80:83] offset:4096
    ds_write_b128 v25, v[84:87] offset:20480
    ds_write_b128 v25, v[88:91] offset:21504
    ds_write_b128 v25, v[92:95] offset:22528
    ds_write_b128 v25, v[96:99] offset:23552
    ds_write_b128 v25, v[100:103] offset:24576
    s_waitcnt vmcnt(10)
    ds_write_b128 v26, v[104:107] offset:0
    ds_write_b128 v26, v[108:111] offset:1024
    ds_write_b128 v26, v[112:115] offset:2048
    ds_write_b128 v26, v[116:119] offset:3072
    ds_write_b128 v26, v[120:123] offset:4096
    ds_write_b128 v26, v[124:127] offset:20480
    ds_write_b128 v26, v[128:131] offset:21504
    ds_write_b128 v26, v[132:135] offset:22528
    ds_write_b128 v26, v[136:139] offset:23552
    ds_write_b128 v26, v[140:143] offset:24576
    s_waitcnt vmcnt(0)
    s_waitcnt lgkmcnt(0)
    s_barrier
F_end:
    s_endpgm
    .p2align 6
F_compute:
    s_mov_b64 exec, 0
    s_cmp_eq_u32 s18, 0
    s_cbranch_scc1 pad_S_0
    s_cmp_eq_u32 s18, 1
    s_cbranch_scc1 pad_S_1
    s_cmp_eq_u32 s18, 2
    s_cbranch_scc1 pad_S_2
    s_branch pad_S_3
S_ret:
    s_mov_b64 exec, -1
    s_waitcnt lgkmcnt(0)
    s_mov_b32 s36, s12
    s_and_b32 s37, s13, 0xffff
    s_mov_b32 s38, 2621440
    s_mov_b32 s39, 0x00020000
    s_mov_b32 s40, s16
    s_and_b32 s41, s17, 0xffff
    s_mov_b32 s42, 268435456
    s_mov_b32 s43, 0x00020000
    s_and_b32 s62, s18, 1
    s_lshr_b32 s63, s18, 1
    v_and_b32 v3, 15, v2
    v_lshrrev_b32 v4, 4, v2
    v_mov_b32 v108, 0
    v_mov_b32 v109, 0
    v_pk_mov_b32 v[110:111], v[108:109], v[108:109]
    v_pk_mov_b32 v[112:113], v[108:109], v[108:109]
    v_pk_mov_b32 v[114:115], v[108:109], v[108:109]
    v_pk_mov_b32 v[116:117], v[108:109], v[108:109]
    v_pk_mov_b32 v[118:119], v[108:109], v[108:109]
    v_pk_mov_b32 v[120:121], v[108:109], v[108:109]
    v_pk_mov_b32 v[122:123], v[108:109], v[108:109]
    v_pk_mov_b32 v[124:125], v[108:109], v[108:109]
    v_pk_mov_b32 v[126:127], v[108:109], v[108:109]
    v_pk_mov_b32 v[128:129], v[108:109], v[108:109]
    v_pk_mov_b32 v[130:131], v[108:109], v[108:109]
    v_pk_mov_b32 v[132:133], v[108:109], v[108:109]
    v_pk_mov_b32 v[134:135], v[108:109], v[108:109]
    v_pk_mov_b32 v[136:137], v[108:109], v[108:109]
    v_pk_mov_b32 v[138:139], v[108:109], v[108:109]
    v_pk_mov_b32 v[140:141], v[108:109], v[108:109]
    v_pk_mov_b32 v[142:143], v[108:109], v[108:109]
    v_pk_mov_b32 v[144:145], v[108:109], v[108:109]
    v_pk_mov_b32 v[146:147], v[108:109], v[108:109]
    v_pk_mov_b32 v[148:149], v[108:109], v[108:109]
    v_pk_mov_b32 v[150:151], v[108:109], v[108:109]
    v_pk_mov_b32 v[152:153], v[108:109], v[108:109]
    v_pk_mov_b32 v[154:155], v[108:109], v[108:109]
    v_pk_mov_b32 v[156:157], v[108:109], v[108:109]
    v_pk_mov_b32 v[158:159], v[108:109], v[108:109]
    v_pk_mov_b32 v[160:161], v[108:109], v[108:109]
    v_pk_mov_b32 v[162:163], v[108:109], v[108:109]
    v_pk_mov_b32 v[164:165], v[108:109], v[108:109]
    v_pk_mov_b32 v[166:167], v[108:109], v[108:109]
    v_pk_mov_b32 v[168:169], v[108:109], v[108:109]
    v_pk_mov_b32 v[170:171], v[108:109], v[108:109]
    v_pk_mov_b32 v[172:173], v[108:109], v[108:109]
    v_pk_mov_b32 v[174:175], v[108:109], v[108:109]
    v_pk_mov_b32 v[176:177], v[108:109], v[108:109]
    v_pk_mov_b32 v[178:179], v[108:109], v[108:109]
    v_pk_mov_b32 v[180:181], v[108:109], v[108:109]
    v_pk_mov_b32 v[182:183], v[108:109], v[108:109]
    v_pk_mov_b32 v[184:185], v[108:109], v[108:109]
    v_pk_mov_b32 v[186:187], v[108:109], v[108:109]
    v_pk_mov_b32 v[188:189], v[108:109], v[108:109]
    v_pk_mov_b32 v[190:191], v[108:109], v[108:109]
    v_pk_mov_b32 v[192:193], v[108:109], v[108:109]
    v_pk_mov_b32 v[194:195], v[108:109], v[108:109]
    v_pk_mov_b32 v[196:197], v[108:109], v[108:109]
    v_pk_mov_b32 v[198:199], v[108:109], v[108:109]
    v_pk_mov_b32 v[200:201], v[108:109], v[108:109]
    v_pk_mov_b32 v[202:203], v[108:109], v[108:109]
    v_pk_mov_b32 v[204:205], v[108:109], v[108:109]
    v_pk_mov_b32 v[206:207], v[108:109], v[108:109]
    v_pk_mov_b32 v[208:209], v[108:109], v[108:109]
    v_pk_mov_b32 v[210:211], v[108:109], v[108:109]
    s_mov_b32 s66, 0xbdd2d3e8
    s_mov_b32 s67, 0xc0135761
    v_mov_b32 v8, 0
    s_mov_b32 s70, 0
    s_mov_b32 s71, 120832
    s_mov_b32 s19, 43008
    s_mul_i32 s56, s53, 10923
    s_lshr_b32 s56, s56, 16
    s_mul_i32 s58, s56, 6
    s_sub_u32 s58, s53, s58
    s_lshr_b32 s54, s52, 2
    s_mul_i32 s54, s54, 5
    s_add_u32 s54, s54, s56
    s_and_b32 s55, s52, 3
    s_mul_i32 s55, s55, 6
    s_add_u32 s55, s55, s58
    s_mul_i32 s51, s54, 13
    s_min_u32 s51, s51, 116
    s_mul_i32 s56, s56, 2
    s_mul_i32 s58, s58, 0
    s_add_u32 s56, s56, s58
    s_mul_i32 s57, s56, 13108
    s_lshr_b32 s57, s57, 16
    s_mul_i32 s57, s57, 5
    s_sub_u32 s56, s56, s57
    s_mul_i32 s56, s56, 8
    s_lshr_b32 s57, s52, 2
    s_mul_i32 s57, s57, 4
    s_add_u32 s56, s56, s57
    s_and_b32 s57, s52, 3
    s_mul_i32 s57, s57, 10
    s_add_u32 s56, s56, s57
    s_lshr_b32 s56, s56, 2
    s_mul_i32 s57, s56, 6554
    s_lshr_b32 s57, s57, 16
    s_mul_i32 s57, s57, 10
    s_sub_u32 s56, s56, s57
    v_and_b32 v5, 1, v4
    v_lshlrev_b32 v5, 1, v5
    v_lshrrev_b32 v6, 3, v3
    v_or_b32 v5, v5, v6
    v_lshrrev_b32 v6, 2, v3
    v_lshl_add_u32 v6, v4, 3, v6
    v_lshlrev_b32 v6, 7, v6
    v_and_b32 v7, 3, v3
    v_lshl_add_u32 v6, v7, 3, v6
    v_add_u32 v6, 147456, v6
    s_lshl_b32 s64, s62, 1
    s_add_u32 s64, s64, s63
    v_xor_b32 v7, s64, v5
    v_lshl_add_u32 v10, v7, 5, v6
    v_xor_b32 v7, 1, v7
    v_lshl_add_u32 v11, v7, 5, v6
    v_lshlrev_b32 v6, 7, v3
    v_add_u32 v6, 120832, v6
    v_lshrrev_b32 v7, 1, v3
    v_xor_b32 v7, v7, v4
    v_lshl_add_u32 v15, v7, 4, v6
    v_xor_b32 v7, 4, v7
    v_lshl_add_u32 v16, v7, 4, v6
    s_mul_i32 s65, s63, 12288
    v_add_u32 v13, s65, v15
    v_add_u32 v14, s65, v16
    s_lshl_b32 s65, s55, 1
    s_add_u32 s65, s65, s62
    s_lshr_b32 s57, s65, 3
    s_lshl_b32 s57, s57, 14
    s_and_b32 s65, s65, 7
    s_lshl_b32 s65, s65, 10
    s_add_u32 s65, s65, s57
    v_and_b32 v7, 31, v2
    v_lshl_add_u32 v7, v7, 4, s65
    s_lshl_b32 s78, s63, 9
    s_xor_b32 s79, s78, 512
    s_mul_i32 s64, s63, 6
    s_add_u32 s64, s64, s51
    v_lshrrev_b32 v6, 5, v2
    v_add_u32 v17, s64, v6
    v_add_u32 v12, 2, v17
    v_add_u32 v222, 4, v17
    s_add_u32 s64, s51, 12
    s_min_u32 s64, s64, 127
    v_mov_b32 v220, s64
    s_mov_b32 s57, 32768
    s_mov_b32 s58, 98304
    v_lshrrev_b32 v5, 6, v17
    v_and_b32 v17, 63, v17
    v_mul_u32_u24 v6, 3121, v17
    v_lshrrev_b32 v6, 16, v6
    v_xor_b32 v5, v5, v6
    v_and_b32 v5, 1, v5
    v_mad_u32_u24 v17, v17, s58, v7
    v_lshl_add_u32 v17, v5, 13, v17
    v_mad_u32_u24 v17, v6, s57, v17
    v_lshrrev_b32 v5, 6, v12
    v_and_b32 v12, 63, v12
    v_mul_u32_u24 v6, 3121, v12
    v_lshrrev_b32 v6, 16, v6
    v_xor_b32 v5, v5, v6
    v_and_b32 v5, 1, v5
    v_mad_u32_u24 v12, v12, s58, v7
    v_lshl_add_u32 v12, v5, 13, v12
    v_mad_u32_u24 v12, v6, s57, v12
    v_lshrrev_b32 v5, 6, v222
    v_and_b32 v222, 63, v222
    v_mul_u32_u24 v6, 3121, v222
    v_lshrrev_b32 v6, 16, v6
    v_xor_b32 v5, v5, v6
    v_and_b32 v5, 1, v5
    v_mad_u32_u24 v222, v222, s58, v7
    v_lshl_add_u32 v222, v5, 13, v222
    v_mad_u32_u24 v222, v6, s57, v222
    v_lshrrev_b32 v5, 6, v220
    v_and_b32 v220, 63, v220
    v_mul_u32_u24 v6, 3121, v220
    v_lshrrev_b32 v6, 16, v6
    v_xor_b32 v5, v5, v6
    v_and_b32 v5, 1, v5
    v_mad_u32_u24 v220, v220, s58, v7
    v_lshl_add_u32 v220, v5, 13, v220
    v_mad_u32_u24 v220, v6, s57, v220
    s_cmp_ge_u32 s55, 12
    s_cselect_b32 s65, 1, 0
    s_mul_i32 s64, s65, 12
    s_sub_u32 s64, s55, s64
    s_lshl_b32 s64, s64, 2
    s_add_u32 s64, s64, s18
    s_lshl_b32 s80, s64, 5
    s_cmp_ge_u32 s54, 5
    s_cselect_b32 s57, 5, 0
    s_cselect_b32 s58, 0, 8192
    s_sub_u32 s64, s54, s57
    s_lshl_b32 s64, s64, 1
    s_add_u32 s64, s64, s65
    s_lshr_b32 s57, s64, 2
    s_lshl_b32 s57, s57, 14
    s_add_u32 s58, s58, s57
    s_and_b32 s64, s64, 3
    s_lshl_b32 s64, s64, 11
    s_add_u32 s64, s64, s58
    s_add_u32 s64, s64, 6422528
    s_add_u32 s64, s64, s80
    v_mov_b32 v9, s64
    s_lshl_b32 s64, s52, 1
    s_add_u32 s64, s64, s53
    s_lshl_b32 s64, s64, 7
    s_add_u32 s64, s64, 4096
    v_writelane_b32 v9, s64, 1
    s_lshr_b32 s64, s53, 1
    s_or_b32 s64, s64, s18
    s_cmp_eq_u32 s64, 0
    s_cselect_b32 s80, 3, 1
    s_mov_b32 s81, 0
    s_mov_b32 s85, 7
    s_barrier
    ds_read_b128 v[36:39], v13 offset:0
    ds_read_b64_tr_b16 v[20:21], v10 offset:0
    ds_read_b64_tr_b16 v[22:23], v10 offset:512
    ds_read_b128 v[40:43], v13 offset:2048
    ds_read_b128 v[44:47], v13 offset:4096
    ds_read_b128 v[48:51], v13 offset:6144
    ds_read_b128 v[52:55], v13 offset:8192
    ds_read_b128 v[56:59], v13 offset:10240
    ds_read_b128 v[60:63], v15 offset:24576
    ds_read_b64_tr_b16 v[24:25], v10 offset:8192
    ds_read_b64_tr_b16 v[26:27], v10 offset:8704
    ds_read_b64_tr_b16 v[28:29], v11 offset:0
    ds_read_b64_tr_b16 v[30:31], v11 offset:512
    ds_read_b64_tr_b16 v[32:33], v11 offset:8192
    ds_read_b64_tr_b16 v[34:35], v11 offset:8704
F_Cloop:
    s_waitcnt lgkmcnt(0)
    v_mfma_f32_16x16x32_bf16 v[108:111], v[20:23], v[36:39], v[108:111]
    ds_read_b128 v[80:83], v14 offset:0
    v_mfma_f32_16x16x32_bf16 v[112:115], v[20:23], v[40:43], v[112:115]
    ds_read_b64_tr_b16 v[64:65], v10 offset:4096
    v_mfma_f32_16x16x32_bf16 v[116:119], v[20:23], v[44:47], v[116:119]
    ds_read_b64_tr_b16 v[66:67], v10 offset:4608
    v_mfma_f32_16x16x32_bf16 v[120:123], v[20:23], v[48:51], v[120:123]
    ds_read_b128 v[84:87], v14 offset:2048
    v_mfma_f32_16x16x32_bf16 v[124:127], v[20:23], v[52:55], v[124:127]
    ds_read_b128 v[88:91], v14 offset:4096
    v_mfma_f32_16x16x32_bf16 v[128:131], v[20:23], v[56:59], v[128:131]
    ds_read_b128 v[92:95], v14 offset:6144
    v_mfma_f32_16x16x32_bf16 v[204:207], v[20:23], v[60:63], v[204:207]
    ds_read_b128 v[96:99], v14 offset:8192
    v_mfma_f32_16x16x32_bf16 v[208:211], v[24:27], v[60:63], v[208:211]
    ds_read_b128 v[100:103], v14 offset:10240
    v_mfma_f32_16x16x32_bf16 v[152:155], v[24:27], v[56:59], v[152:155]
    ds_read_b128 v[104:107], v16 offset:24576
    v_mfma_f32_16x16x32_bf16 v[148:151], v[24:27], v[52:55], v[148:151]
    ds_read_b64_tr_b16 v[68:69], v10 offset:12288
    v_mfma_f32_16x16x32_bf16 v[144:147], v[24:27], v[48:51], v[144:147]
    ds_read_b64_tr_b16 v[70:71], v10 offset:12800
    v_mfma_f32_16x16x32_bf16 v[140:143], v[24:27], v[44:47], v[140:143]
    ds_read_b64_tr_b16 v[72:73], v11 offset:4096
    v_mfma_f32_16x16x32_bf16 v[136:139], v[24:27], v[40:43], v[136:139]
    ds_read_b64_tr_b16 v[74:75], v11 offset:4608
    v_mfma_f32_16x16x32_bf16 v[132:135], v[24:27], v[36:39], v[132:135]
    ds_read_b64_tr_b16 v[76:77], v11 offset:12288
    v_mfma_f32_16x16x32_bf16 v[156:159], v[28:31], v[36:39], v[156:159]
    ds_read_b64_tr_b16 v[78:79], v11 offset:12800
    v_mfma_f32_16x16x32_bf16 v[160:163], v[28:31], v[40:43], v[160:163]
    s_cmp_eq_u32 s71, 120832
    s_cselect_b32 s65, 0xfffeb000, s19
    s_add_u32 s71, s71, s65
    v_mfma_f32_16x16x32_bf16 v[164:167], v[28:31], v[44:47], v[164:167]
    v_add_u32 v10, s65, v10
    v_mfma_f32_16x16x32_bf16 v[168:171], v[28:31], v[48:51], v[168:171]
    v_add_u32 v11, s65, v11
    v_mfma_f32_16x16x32_bf16 v[172:175], v[28:31], v[52:55], v[172:175]
    v_add_u32 v13, s65, v13
    v_mfma_f32_16x16x32_bf16 v[176:179], v[28:31], v[56:59], v[176:179]
    v_add_u32 v14, s65, v14
    v_mfma_f32_16x16x32_bf16 v[200:203], v[32:35], v[56:59], v[200:203]
    v_add_u32 v15, s65, v15
    v_mfma_f32_16x16x32_bf16 v[196:199], v[32:35], v[52:55], v[196:199]
    v_add_u32 v16, s65, v16
    v_mfma_f32_16x16x32_bf16 v[192:195], v[32:35], v[48:51], v[192:195]
    v_mfma_f32_16x16x32_bf16 v[188:191], v[32:35], v[44:47], v[188:191]
    v_mfma_f32_16x16x32_bf16 v[184:187], v[32:35], v[40:43], v[184:187]
    v_mfma_f32_16x16x32_bf16 v[180:183], v[32:35], v[36:39], v[180:183]
    s_waitcnt lgkmcnt(0)
    v_mfma_f32_16x16x32_bf16 v[108:111], v[64:67], v[80:83], v[108:111]
    v_mfma_f32_16x16x32_bf16 v[112:115], v[64:67], v[84:87], v[112:115]
    v_mfma_f32_16x16x32_bf16 v[116:119], v[64:67], v[88:91], v[116:119]
    v_mfma_f32_16x16x32_bf16 v[120:123], v[64:67], v[92:95], v[120:123]
    v_mfma_f32_16x16x32_bf16 v[124:127], v[64:67], v[96:99], v[124:127]
    v_mfma_f32_16x16x32_bf16 v[128:131], v[64:67], v[100:103], v[128:131]
    v_mfma_f32_16x16x32_bf16 v[204:207], v[64:67], v[104:107], v[204:207]
    v_mfma_f32_16x16x32_bf16 v[208:211], v[68:71], v[104:107], v[208:211]
    s_barrier
    v_mfma_f32_16x16x32_bf16 v[152:155], v[68:71], v[100:103], v[152:155]
    ds_read_b128 v[36:39], v13 offset:0
    v_mfma_f32_16x16x32_bf16 v[148:151], v[68:71], v[96:99], v[148:151]
    ds_read_b64_tr_b16 v[20:21], v10 offset:0
    v_mfma_f32_16x16x32_bf16 v[144:147], v[68:71], v[92:95], v[144:147]
    ds_read_b64_tr_b16 v[22:23], v10 offset:512
    v_mfma_f32_16x16x32_bf16 v[140:143], v[68:71], v[88:91], v[140:143]
    ds_read_b128 v[40:43], v13 offset:2048
    v_mfma_f32_16x16x32_bf16 v[136:139], v[68:71], v[84:87], v[136:139]
    ds_read_b128 v[44:47], v13 offset:4096
    v_mfma_f32_16x16x32_bf16 v[132:135], v[68:71], v[80:83], v[132:135]
    ds_read_b128 v[48:51], v13 offset:6144
    v_mfma_f32_16x16x32_bf16 v[156:159], v[72:75], v[80:83], v[156:159]
    ds_read_b128 v[52:55], v13 offset:8192
    v_mfma_f32_16x16x32_bf16 v[160:163], v[72:75], v[84:87], v[160:163]
    ds_read_b128 v[56:59], v13 offset:10240
    v_mfma_f32_16x16x32_bf16 v[164:167], v[72:75], v[88:91], v[164:167]
    ds_read_b128 v[60:63], v15 offset:24576
    v_mfma_f32_16x16x32_bf16 v[168:171], v[72:75], v[92:95], v[168:171]
    ds_read_b64_tr_b16 v[24:25], v10 offset:8192
    v_mfma_f32_16x16x32_bf16 v[172:175], v[72:75], v[96:99], v[172:175]
    ds_read_b64_tr_b16 v[26:27], v10 offset:8704
    v_mfma_f32_16x16x32_bf16 v[176:179], v[72:75], v[100:103], v[176:179]
    ds_read_b64_tr_b16 v[28:29], v11 offset:0
    v_mfma_f32_16x16x32_bf16 v[200:203], v[76:79], v[100:103], v[200:203]
    ds_read_b64_tr_b16 v[30:31], v11 offset:512
    v_mfma_f32_16x16x32_bf16 v[196:199], v[76:79], v[96:99], v[196:199]
    ds_read_b64_tr_b16 v[32:33], v11 offset:8192
    v_mfma_f32_16x16x32_bf16 v[192:195], v[76:79], v[92:95], v[192:195]
    ds_read_b64_tr_b16 v[34:35], v11 offset:8704
    v_mfma_f32_16x16x32_bf16 v[188:191], v[76:79], v[88:91], v[188:191]
    s_add_u32 s70, s70, 1
    s_cmp_lg_u32 s70, s85
    v_mfma_f32_16x16x32_bf16 v[184:187], v[76:79], v[84:87], v[184:187]
    v_mfma_f32_16x16x32_bf16 v[180:183], v[76:79], v[80:83], v[180:183]
    s_cbranch_scc1 F_Cloop
    s_cmp_eq_u32 s70, 10
    s_cbranch_scc1 F_done
    ds_read_b64 v[18:19], v8
    ds_read_b32 v221, v8 offset:8
    s_mov_b32 s85, 10
    s_branch F_Cloop
F_done:
    s_waitcnt lgkmcnt(0)
    v_xor_b32 v17, v17, v221
    v_xor_b32 v12, v12, v221
    v_xor_b32 v222, v222, v221
    v_xor_b32 v220, v220, v221
    s_mov_b64 exec, 1
    v_xor_b32 v9, v9, v221
    s_mov_b64 exec, -1
    s_cmp_ge_u32 s54, 8
    s_cbranch_scc1 F_no13
    v_pk_mul_f32 v[36:37], v[204:205], v[204:205]
    v_pk_mul_f32 v[38:39], v[206:207], v[206:207]
    v_pk_fma_f32 v[36:37], v[36:37], s[66:67], s[66:67] op_sel:[0,0,1] op_sel_hi:[1,0,1]
    v_pk_fma_f32 v[38:39], v[38:39], s[66:67], s[66:67] op_sel:[0,0,1] op_sel_hi:[1,0,1]
    v_pk_mul_f32 v[36:37], v[36:37], v[204:205]
    v_pk_mul_f32 v[38:39], v[38:39], v[206:207]
    v_exp_f32 v36, v36
    v_exp_f32 v37, v37
    v_exp_f32 v38, v38
    v_exp_f32 v39, v39
    v_pk_add_f32 v[36:37], v[36:37], 1.0 op_sel_hi:[1,0]
    v_pk_add_f32 v[38:39], v[38:39], 1.0 op_sel_hi:[1,0]
    v_rcp_f32 v36, v36
    v_rcp_f32 v37, v37
    v_rcp_f32 v38, v38
    v_rcp_f32 v39, v39
    v_pk_mul_f32 v[36:37], v[36:37], v[204:205]
    v_pk_mul_f32 v[38:39], v[38:39], v[206:207]
    v_pk_mul_f32 v[36:37], v[36:37], v[208:209]
    v_pk_mul_f32 v[38:39], v[38:39], v[210:211]
    v_cvt_pk_bf16_f32 v40, v36, v37
    v_cvt_pk_bf16_f32 v41, v38, v39
    v_cvt_pk_bf16_f32 v42, v36, v37
    v_cvt_pk_bf16_f32 v43, v38, v39
    s_nop 0
    v_permlane32_swap_b32 v40, v42
    v_permlane32_swap_b32 v41, v43
    s_mov_b32 exec_hi, 0
    buffer_store_dwordx4 v[40:43], v220, s[40:43], s78 offen sc1
    s_mov_b32 exec_hi, -1
F_no13:
    v_pk_mul_f32 v[20:21], v[108:109], v[108:109]
    v_pk_mul_f32 v[22:23], v[110:111], v[110:111]
    v_pk_mul_f32 v[24:25], v[112:113], v[112:113]
    v_pk_mul_f32 v[26:27], v[114:115], v[114:115]
    v_pk_fma_f32 v[20:21], v[20:21], s[66:67], s[66:67] op_sel:[0,0,1] op_sel_hi:[1,0,1]
    v_pk_fma_f32 v[22:23], v[22:23], s[66:67], s[66:67] op_sel:[0,0,1] op_sel_hi:[1,0,1]
    v_pk_fma_f32 v[24:25], v[24:25], s[66:67], s[66:67] op_sel:[0,0,1] op_sel_hi:[1,0,1]
    v_pk_fma_f32 v[26:27], v[26:27], s[66:67], s[66:67] op_sel:[0,0,1] op_sel_hi:[1,0,1]
    v_pk_mul_f32 v[20:21], v[20:21], v[108:109]
    v_pk_mul_f32 v[22:23], v[22:23], v[110:111]
    v_pk_mul_f32 v[24:25], v[24:25], v[112:113]
    v_pk_mul_f32 v[26:27], v[26:27], v[114:115]
    v_exp_f32 v20, v20
    v_exp_f32 v21, v21
    v_exp_f32 v22, v22
    v_exp_f32 v23, v23
    v_exp_f32 v24, v24
    v_exp_f32 v25, v25
    v_exp_f32 v26, v26
    v_exp_f32 v27, v27
    v_pk_add_f32 v[20:21], v[20:21], 1.0 op_sel_hi:[1,0]
    v_pk_add_f32 v[22:23], v[22:23], 1.0 op_sel_hi:[1,0]
    v_pk_add_f32 v[24:25], v[24:25], 1.0 op_sel_hi:[1,0]
    v_pk_add_f32 v[26:27], v[26:27], 1.0 op_sel_hi:[1,0]
    v_rcp_f32 v20, v20
    v_rcp_f32 v21, v21
    v_rcp_f32 v22, v22
    v_rcp_f32 v23, v23
    v_rcp_f32 v24, v24
    v_rcp_f32 v25, v25
    v_rcp_f32 v26, v26
    v_rcp_f32 v27, v27
    v_pk_mul_f32 v[20:21], v[20:21], v[108:109]
    v_pk_mul_f32 v[22:23], v[22:23], v[110:111]
    v_pk_mul_f32 v[24:25], v[24:25], v[112:113]
    v_pk_mul_f32 v[26:27], v[26:27], v[114:115]
    v_pk_mul_f32 v[20:21], v[20:21], v[132:133]
    v_pk_mul_f32 v[22:23], v[22:23], v[134:135]
    v_pk_mul_f32 v[24:25], v[24:25], v[136:137]
    v_pk_mul_f32 v[26:27], v[26:27], v[138:139]
    v_cvt_pk_bf16_f32 v212, v20, v21
    v_cvt_pk_bf16_f32 v213, v22, v23
    v_cvt_pk_bf16_f32 v214, v24, v25
    v_cvt_pk_bf16_f32 v215, v26, v27
    s_nop 0
    v_permlane32_swap_b32 v212, v214
    v_permlane32_swap_b32 v213, v215
    buffer_store_dwordx4 v[212:215], v17, s[40:43], s78 offen sc1
    v_pk_mul_f32 v[28:29], v[116:117], v[116:117]
    v_pk_mul_f32 v[30:31], v[118:119], v[118:119]
    v_pk_mul_f32 v[32:33], v[120:121], v[120:121]
    v_pk_mul_f32 v[34:35], v[122:123], v[122:123]
    v_pk_fma_f32 v[28:29], v[28:29], s[66:67], s[66:67] op_sel:[0,0,1] op_sel_hi:[1,0,1]
    v_pk_fma_f32 v[30:31], v[30:31], s[66:67], s[66:67] op_sel:[0,0,1] op_sel_hi:[1,0,1]
    v_pk_fma_f32 v[32:33], v[32:33], s[66:67], s[66:67] op_sel:[0,0,1] op_sel_hi:[1,0,1]
    v_pk_fma_f32 v[34:35], v[34:35], s[66:67], s[66:67] op_sel:[0,0,1] op_sel_hi:[1,0,1]
    v_pk_mul_f32 v[28:29], v[28:29], v[116:117]
    v_pk_mul_f32 v[30:31], v[30:31], v[118:119]
    v_pk_mul_f32 v[32:33], v[32:33], v[120:121]
    v_pk_mul_f32 v[34:35], v[34:35], v[122:123]
    v_exp_f32 v28, v28
    v_exp_f32 v29, v29
    v_exp_f32 v30, v30
    v_exp_f32 v31, v31
    v_exp_f32 v32, v32
    v_exp_f32 v33, v33
    v_exp_f32 v34, v34
    v_exp_f32 v35, v35
    v_pk_add_f32 v[28:29], v[28:29], 1.0 op_sel_hi:[1,0]
    v_pk_add_f32 v[30:31], v[30:31], 1.0 op_sel_hi:[1,0]
    v_pk_add_f32 v[32:33], v[32:33], 1.0 op_sel_hi:[1,0]
    v_pk_add_f32 v[34:35], v[34:35], 1.0 op_sel_hi:[1,0]
    v_rcp_f32 v28, v28
    v_rcp_f32 v29, v29
    v_rcp_f32 v30, v30
    v_rcp_f32 v31, v31
    v_rcp_f32 v32, v32
    v_rcp_f32 v33, v33
    v_rcp_f32 v34, v34
    v_rcp_f32 v35, v35
    v_pk_mul_f32 v[28:29], v[28:29], v[116:117]
    v_pk_mul_f32 v[30:31], v[30:31], v[118:119]
    v_pk_mul_f32 v[32:33], v[32:33], v[120:121]
    v_pk_mul_f32 v[34:35], v[34:35], v[122:123]
    v_pk_mul_f32 v[28:29], v[28:29], v[140:141]
    v_pk_mul_f32 v[30:31], v[30:31], v[142:143]
    v_pk_mul_f32 v[32:33], v[32:33], v[144:145]
    v_pk_mul_f32 v[34:35], v[34:35], v[146:147]
    v_cvt_pk_bf16_f32 v216, v28, v29
    v_cvt_pk_bf16_f32 v217, v30, v31
    v_cvt_pk_bf16_f32 v218, v32, v33
    v_cvt_pk_bf16_f32 v219, v34, v35
    s_nop 0
    v_permlane32_swap_b32 v216, v218
    v_permlane32_swap_b32 v217, v219
    buffer_store_dwordx4 v[216:219], v12, s[40:43], s78 offen sc1
    v_pk_mul_f32 v[20:21], v[124:125], v[124:125]
    v_pk_mul_f32 v[22:23], v[126:127], v[126:127]
    v_pk_mul_f32 v[24:25], v[128:129], v[128:129]
    v_pk_mul_f32 v[26:27], v[130:131], v[130:131]
    v_pk_fma_f32 v[20:21], v[20:21], s[66:67], s[66:67] op_sel:[0,0,1] op_sel_hi:[1,0,1]
    v_pk_fma_f32 v[22:23], v[22:23], s[66:67], s[66:67] op_sel:[0,0,1] op_sel_hi:[1,0,1]
    v_pk_fma_f32 v[24:25], v[24:25], s[66:67], s[66:67] op_sel:[0,0,1] op_sel_hi:[1,0,1]
    v_pk_fma_f32 v[26:27], v[26:27], s[66:67], s[66:67] op_sel:[0,0,1] op_sel_hi:[1,0,1]
    v_pk_mul_f32 v[20:21], v[20:21], v[124:125]
    v_pk_mul_f32 v[22:23], v[22:23], v[126:127]
    v_pk_mul_f32 v[24:25], v[24:25], v[128:129]
    v_pk_mul_f32 v[26:27], v[26:27], v[130:131]
    v_exp_f32 v20, v20
    v_exp_f32 v21, v21
    v_exp_f32 v22, v22
    v_exp_f32 v23, v23
    v_exp_f32 v24, v24
    v_exp_f32 v25, v25
    v_exp_f32 v26, v26
    v_exp_f32 v27, v27
    v_pk_add_f32 v[20:21], v[20:21], 1.0 op_sel_hi:[1,0]
    v_pk_add_f32 v[22:23], v[22:23], 1.0 op_sel_hi:[1,0]
    v_pk_add_f32 v[24:25], v[24:25], 1.0 op_sel_hi:[1,0]
    v_pk_add_f32 v[26:27], v[26:27], 1.0 op_sel_hi:[1,0]
    v_rcp_f32 v20, v20
pad_S_1:
    s_cbranch_execz S_ret
    v_rcp_f32 v21, v21
    v_rcp_f32 v22, v22
    v_rcp_f32 v23, v23
    v_rcp_f32 v24, v24
    v_rcp_f32 v25, v25
    v_rcp_f32 v26, v26
    v_rcp_f32 v27, v27
    v_pk_mul_f32 v[20:21], v[20:21], v[124:125]
    v_pk_mul_f32 v[22:23], v[22:23], v[126:127]
    v_pk_mul_f32 v[24:25], v[24:25], v[128:129]
    v_pk_mul_f32 v[26:27], v[26:27], v[130:131]
    v_pk_mul_f32 v[20:21], v[20:21], v[148:149]
    v_pk_mul_f32 v[22:23], v[22:23], v[150:151]
    v_pk_mul_f32 v[24:25], v[24:25], v[152:153]
    v_pk_mul_f32 v[26:27], v[26:27], v[154:155]
    v_cvt_pk_bf16_f32 v212, v20, v21
    v_cvt_pk_bf16_f32 v213, v22, v23
    v_cvt_pk_bf16_f32 v214, v24, v25
    v_cvt_pk_bf16_f32 v215, v26, v27
    s_nop 0
    v_permlane32_swap_b32 v212, v214
    v_permlane32_swap_b32 v213, v215
    buffer_store_dwordx4 v[212:215], v222, s[40:43], s78 offen sc1
    v_pk_mul_f32 v[28:29], v[156:157], v[156:157]
    v_pk_mul_f32 v[30:31], v[158:159], v[158:159]
    v_pk_mul_f32 v[32:33], v[160:161], v[160:161]
    v_pk_mul_f32 v[34:35], v[162:163], v[162:163]
    v_pk_fma_f32 v[28:29], v[28:29], s[66:67], s[66:67] op_sel:[0,0,1] op_sel_hi:[1,0,1]
    v_pk_fma_f32 v[30:31], v[30:31], s[66:67], s[66:67] op_sel:[0,0,1] op_sel_hi:[1,0,1]
    v_pk_fma_f32 v[32:33], v[32:33], s[66:67], s[66:67] op_sel:[0,0,1] op_sel_hi:[1,0,1]
    v_pk_fma_f32 v[34:35], v[34:35], s[66:67], s[66:67] op_sel:[0,0,1] op_sel_hi:[1,0,1]
    v_pk_mul_f32 v[28:29], v[28:29], v[156:157]
    v_pk_mul_f32 v[30:31], v[30:31], v[158:159]
    v_pk_mul_f32 v[32:33], v[32:33], v[160:161]
    v_pk_mul_f32 v[34:35], v[34:35], v[162:163]
    v_exp_f32 v28, v28
    v_exp_f32 v29, v29
    v_exp_f32 v30, v30
    v_exp_f32 v31, v31
    v_exp_f32 v32, v32
    v_exp_f32 v33, v33
    v_exp_f32 v34, v34
    v_exp_f32 v35, v35
    v_pk_add_f32 v[28:29], v[28:29], 1.0 op_sel_hi:[1,0]
    v_pk_add_f32 v[30:31], v[30:31], 1.0 op_sel_hi:[1,0]
    v_pk_add_f32 v[32:33], v[32:33], 1.0 op_sel_hi:[1,0]
    v_pk_add_f32 v[34:35], v[34:35], 1.0 op_sel_hi:[1,0]
    v_rcp_f32 v28, v28
    v_rcp_f32 v29, v29
    v_rcp_f32 v30, v30
    v_rcp_f32 v31, v31
    v_rcp_f32 v32, v32
    v_rcp_f32 v33, v33
    v_rcp_f32 v34, v34
    v_rcp_f32 v35, v35
    v_pk_mul_f32 v[28:29], v[28:29], v[156:157]
    v_pk_mul_f32 v[30:31], v[30:31], v[158:159]
    v_pk_mul_f32 v[32:33], v[32:33], v[160:161]
    v_pk_mul_f32 v[34:35], v[34:35], v[162:163]
    v_pk_mul_f32 v[28:29], v[28:29], v[180:181]
    v_pk_mul_f32 v[30:31], v[30:31], v[182:183]
    v_pk_mul_f32 v[32:33], v[32:33], v[184:185]
    v_pk_mul_f32 v[34:35], v[34:35], v[186:187]
    v_cvt_pk_bf16_f32 v216, v28, v29
    v_cvt_pk_bf16_f32 v217, v30, v31
    v_cvt_pk_bf16_f32 v218, v32, v33
    v_cvt_pk_bf16_f32 v219, v34, v35
    s_nop 0
    v_permlane32_swap_b32 v216, v218
    v_permlane32_swap_b32 v217, v219
    buffer_store_dwordx4 v[216:219], v17, s[40:43], s79 offen sc1
    v_pk_mul_f32 v[20:21], v[164:165], v[164:165]
    v_pk_mul_f32 v[22:23], v[166:167], v[166:167]
    v_pk_mul_f32 v[24:25], v[168:169], v[168:169]
    v_pk_mul_f32 v[26:27], v[170:171], v[170:171]
    v_pk_fma_f32 v[20:21], v[20:21], s[66:67], s[66:67] op_sel:[0,0,1] op_sel_hi:[1,0,1]
    v_pk_fma_f32 v[22:23], v[22:23], s[66:67], s[66:67] op_sel:[0,0,1] op_sel_hi:[1,0,1]
    v_pk_fma_f32 v[24:25], v[24:25], s[66:67], s[66:67] op_sel:[0,0,1] op_sel_hi:[1,0,1]
    v_pk_fma_f32 v[26:27], v[26:27], s[66:67], s[66:67] op_sel:[0,0,1] op_sel_hi:[1,0,1]
    v_pk_mul_f32 v[20:21], v[20:21], v[164:165]
    v_pk_mul_f32 v[22:23], v[22:23], v[166:167]
    v_pk_mul_f32 v[24:25], v[24:25], v[168:169]
    v_pk_mul_f32 v[26:27], v[26:27], v[170:171]
    v_exp_f32 v20, v20
    v_exp_f32 v21, v21
    v_exp_f32 v22, v22
    v_exp_f32 v23, v23
    v_exp_f32 v24, v24
    v_exp_f32 v25, v25
    v_exp_f32 v26, v26
    v_exp_f32 v27, v27
    v_pk_add_f32 v[20:21], v[20:21], 1.0 op_sel_hi:[1,0]
    v_pk_add_f32 v[22:23], v[22:23], 1.0 op_sel_hi:[1,0]
    v_pk_add_f32 v[24:25], v[24:25], 1.0 op_sel_hi:[1,0]
    v_pk_add_f32 v[26:27], v[26:27], 1.0 op_sel_hi:[1,0]
    v_rcp_f32 v20, v20
    v_rcp_f32 v21, v21
    v_rcp_f32 v22, v22
    v_rcp_f32 v23, v23
    v_rcp_f32 v24, v24
    v_rcp_f32 v25, v25
    v_rcp_f32 v26, v26
    v_rcp_f32 v27, v27
    v_pk_mul_f32 v[20:21], v[20:21], v[164:165]
    v_pk_mul_f32 v[22:23], v[22:23], v[166:167]
    v_pk_mul_f32 v[24:25], v[24:25], v[168:169]
    v_pk_mul_f32 v[26:27], v[26:27], v[170:171]
    v_pk_mul_f32 v[20:21], v[20:21], v[188:189]
    v_pk_mul_f32 v[22:23], v[22:23], v[190:191]
    v_pk_mul_f32 v[24:25], v[24:25], v[192:193]
    v_pk_mul_f32 v[26:27], v[26:27], v[194:195]
    v_cvt_pk_bf16_f32 v212, v20, v21
    v_cvt_pk_bf16_f32 v213, v22, v23
    v_cvt_pk_bf16_f32 v214, v24, v25
    v_cvt_pk_bf16_f32 v215, v26, v27
    s_nop 0
    v_permlane32_swap_b32 v212, v214
    v_permlane32_swap_b32 v213, v215
    buffer_store_dwordx4 v[212:215], v12, s[40:43], s79 offen sc1
    v_pk_mul_f32 v[28:29], v[172:173], v[172:173]
    v_pk_mul_f32 v[30:31], v[174:175], v[174:175]
    v_pk_mul_f32 v[32:33], v[176:177], v[176:177]
    v_pk_mul_f32 v[34:35], v[178:179], v[178:179]
    v_pk_fma_f32 v[28:29], v[28:29], s[66:67], s[66:67] op_sel:[0,0,1] op_sel_hi:[1,0,1]
    v_pk_fma_f32 v[30:31], v[30:31], s[66:67], s[66:67] op_sel:[0,0,1] op_sel_hi:[1,0,1]
    v_pk_fma_f32 v[32:33], v[32:33], s[66:67], s[66:67] op_sel:[0,0,1] op_sel_hi:[1,0,1]
    v_pk_fma_f32 v[34:35], v[34:35], s[66:67], s[66:67] op_sel:[0,0,1] op_sel_hi:[1,0,1]
    v_pk_mul_f32 v[28:29], v[28:29], v[172:173]
    v_pk_mul_f32 v[30:31], v[30:31], v[174:175]
    v_pk_mul_f32 v[32:33], v[32:33], v[176:177]
    v_pk_mul_f32 v[34:35], v[34:35], v[178:179]
    v_exp_f32 v28, v28
    v_exp_f32 v29, v29
    v_exp_f32 v30, v30
    v_exp_f32 v31, v31
    v_exp_f32 v32, v32
    v_exp_f32 v33, v33
    v_exp_f32 v34, v34
    v_exp_f32 v35, v35
    v_pk_add_f32 v[28:29], v[28:29], 1.0 op_sel_hi:[1,0]
    v_pk_add_f32 v[30:31], v[30:31], 1.0 op_sel_hi:[1,0]
    v_pk_add_f32 v[32:33], v[32:33], 1.0 op_sel_hi:[1,0]
    v_pk_add_f32 v[34:35], v[34:35], 1.0 op_sel_hi:[1,0]
    v_rcp_f32 v28, v28
    v_rcp_f32 v29, v29
    v_rcp_f32 v30, v30
    v_rcp_f32 v31, v31
    v_rcp_f32 v32, v32
    v_rcp_f32 v33, v33
    v_rcp_f32 v34, v34
    v_rcp_f32 v35, v35
    v_pk_mul_f32 v[28:29], v[28:29], v[172:173]
    v_pk_mul_f32 v[30:31], v[30:31], v[174:175]
    v_pk_mul_f32 v[32:33], v[32:33], v[176:177]
    v_pk_mul_f32 v[34:35], v[34:35], v[178:179]
    v_pk_mul_f32 v[28:29], v[28:29], v[196:197]
    v_pk_mul_f32 v[30:31], v[30:31], v[198:199]
    v_pk_mul_f32 v[32:33], v[32:33], v[200:201]
    v_pk_mul_f32 v[34:35], v[34:35], v[202:203]
    v_cvt_pk_bf16_f32 v216, v28, v29
pad_S_2:
    s_cbranch_execz S_ret
    v_cvt_pk_bf16_f32 v217, v30, v31
    v_cvt_pk_bf16_f32 v218, v32, v33
    v_cvt_pk_bf16_f32 v219, v34, v35
    s_nop 0
    v_permlane32_swap_b32 v216, v218
    v_permlane32_swap_b32 v217, v219
    buffer_store_dwordx4 v[216:219], v222, s[40:43], s79 offen sc1
    s_waitcnt vmcnt(0)
    s_mov_b64 exec, s[80:81]
    buffer_store_dwordx2 v[18:19], v9, s[40:43], 0 offen sc1
    s_mov_b64 exec, -1
    s_lshr_b32 s57, s53, 2
    s_and_b32 s58, s53, 3
    s_lshr_b32 s59, s52, 2
    s_lshl_b32 s59, s59, 1
    s_and_b32 s60, s52, 1
    s_add_u32 s59, s59, s60
    s_lshl_b32 s59, s59, 3
    s_add_u32 s59, s59, s57
    s_bfe_u32 s60, s52, 0x10001
    s_lshl_b32 s60, s60, 2
    s_add_u32 s60, s60, s58
    s_mul_i32 s57, s57, 3
    s_mul_i32 s58, s58, 0
    s_add_u32 s61, s57, s58
    s_lshr_b32 s61, s61, 2
    s_mul_i32 s57, s61, 10923
    s_lshr_b32 s57, s57, 16
    s_mul_i32 s57, s57, 6
    s_sub_u32 s61, s61, s57
    v_min_u32 v5, 47, v2
    s_lshl_b32 s64, s59, 2
    s_add_u32 s64, s64, 0
    s_cmp_ge_u32 s64, 116
    s_addc_u32 s64, s64, 0
    s_mul_i32 s64, s64, 5042
    s_lshr_b32 s64, s64, 16
    s_cmp_ge_u32 s64, 5
    s_cselect_b32 s57, 5, 0
    s_cselect_b32 s58, 0, 8192
    s_sub_u32 s65, s64, s57
    s_lshl_b32 s65, s65, 1
    s_add_u32 s65, s65, s62
    s_lshr_b32 s57, s65, 2
    s_lshl_b32 s57, s57, 14
    s_add_u32 s58, s58, s57
    s_and_b32 s65, s65, 3
    s_lshl_b32 s65, s65, 11
    s_add_u32 s65, s65, s58
    s_add_u32 s65, s65, 6422528
    v_lshl_add_u32 v252, v5, 5, s65
    s_lshl_b32 s64, s59, 2
    s_add_u32 s64, s64, 3
    s_cmp_ge_u32 s64, 116
    s_addc_u32 s64, s64, 0
    s_mul_i32 s64, s64, 5042
    s_lshr_b32 s64, s64, 16
    s_cmp_ge_u32 s64, 5
    s_cselect_b32 s57, 5, 0
    s_cselect_b32 s58, 0, 8192
    s_sub_u32 s65, s64, s57
    s_lshl_b32 s65, s65, 1
    s_add_u32 s65, s65, s62
    s_lshr_b32 s57, s65, 2
    s_lshl_b32 s57, s57, 14
    s_add_u32 s58, s58, s57
    s_and_b32 s65, s65, 3
    s_lshl_b32 s65, s65, 11
    s_add_u32 s65, s65, s58
    s_add_u32 s65, s65, 6422528
    v_lshl_add_u32 v253, v5, 5, s65
    v_lshrrev_b32 v5, 1, v4
    v_lshlrev_b32 v5, 4, v5
    v_and_b32 v6, 1, v4
    v_lshl_add_u32 v5, v6, 2, v5
    v_lshrrev_b32 v6, 2, v3
    v_add_u32 v5, v5, v6
    v_and_b32 v6, 3, v3
    v_lshlrev_b32 v6, 3, v6
    s_mul_i32 s64, s62, 20480
    v_add_u32 v6, s64, v6
    v_lshl_add_u32 v7, v5, 5, v6
    v_add_u32 v242, 4096, v7
    v_lshl_add_u32 v6, v5, 7, v6
    v_bfe_u32 v5, v5, 1, 2
    v_xor_b32 v7, 0, v5
    v_lshl_add_u32 v238, v7, 5, v6
    v_xor_b32 v7, 1, v5
    v_lshl_add_u32 v239, v7, 5, v6
    v_xor_b32 v7, 2, v5
    v_lshl_add_u32 v240, v7, 5, v6
    v_xor_b32 v7, 3, v5
    v_lshl_add_u32 v241, v7, 5, v6
    s_lshl_b32 s64, s59, 2
    s_lshl_b32 s65, s63, 1
    s_add_u32 s64, s64, s65
    s_add_u32 s65, s64, 1
    s_lshr_b32 s57, s64, 6
    s_and_b32 s64, s64, 63
    s_mul_i32 s58, s64, 3121
    s_lshr_b32 s58, s58, 16
    s_xor_b32 s57, s57, s58
    s_and_b32 s57, s57, 1
    s_lshl_b32 s57, s57, 13
    s_mul_i32 s58, s58, 32768
    s_mul_i32 s64, s64, 98304
    s_add_u32 s64, s64, s58
    s_add_u32 s64, s64, s57
    s_lshr_b32 s57, s65, 6
    s_and_b32 s65, s65, 63
    s_mul_i32 s58, s65, 3121
    s_lshr_b32 s58, s58, 16
    s_xor_b32 s57, s57, s58
    s_and_b32 s57, s57, 1
    s_lshl_b32 s57, s57, 13
    s_mul_i32 s58, s58, 32768
    s_mul_i32 s65, s65, 98304
    s_add_u32 s65, s65, s58
    s_add_u32 s65, s65, s57
    v_lshl_add_u32 v236, v2, 4, s64
    v_lshl_add_u32 v237, v2, 4, s65
    s_mul_i32 s64, s62, 6
    s_add_u32 s64, s64, s61
    s_lshr_b32 s65, s64, 1
    s_lshl_b32 s65, s65, 14
    s_and_b32 s64, s64, 1
    s_lshl_b32 s64, s64, 12
    s_add_u32 s96, s64, s65
    s_add_u32 s61, s61, 1
    s_cmp_eq_u32 s61, 6
    s_cselect_b32 s61, 0, s61
    s_mul_i32 s64, s62, 6
    s_add_u32 s64, s64, s61
    s_lshr_b32 s65, s64, 1
    s_lshl_b32 s65, s65, 14
    s_and_b32 s64, s64, 1
    s_lshl_b32 s64, s64, 12
    s_add_u32 s97, s64, s65
    s_add_u32 s61, s61, 1
    s_cmp_eq_u32 s61, 6
    s_cselect_b32 s61, 0, s61
    s_mul_i32 s64, s62, 6
    s_add_u32 s64, s64, s61
    s_lshr_b32 s65, s64, 1
    s_lshl_b32 s65, s65, 14
    s_and_b32 s64, s64, 1
    s_lshl_b32 s64, s64, 12
    s_add_u32 s98, s64, s65
    s_add_u32 s61, s61, 1
    s_cmp_eq_u32 s61, 6
    s_cselect_b32 s61, 0, s61
    s_mul_i32 s64, s62, 6
    s_add_u32 s64, s64, s61
    s_lshr_b32 s65, s64, 1
    s_lshl_b32 s65, s65, 14
    s_and_b32 s64, s64, 1
    s_lshl_b32 s64, s64, 12
    s_add_u32 s99, s64, s65
    s_add_u32 s61, s61, 1
    s_cmp_eq_u32 s61, 6
    s_cselect_b32 s61, 0, s61
    s_mul_i32 s64, s62, 6
    s_add_u32 s64, s64, s61
    s_lshr_b32 s65, s64, 1
    s_lshl_b32 s65, s65, 14
    s_and_b32 s64, s64, 1
    s_lshl_b32 s64, s64, 12
    s_add_u32 s100, s64, s65
    s_add_u32 s61, s61, 1
    s_cmp_eq_u32 s61, 6
    s_cselect_b32 s61, 0, s61
    s_mul_i32 s64, s62, 6
    s_add_u32 s64, s64, s61
    s_lshr_b32 s65, s64, 1
    s_lshl_b32 s65, s65, 14
    s_and_b32 s64, s64, 1
    s_lshl_b32 s64, s64, 12
    s_add_u32 s101, s64, s65
    s_add_u32 s61, s61, 1
    s_cmp_eq_u32 s61, 6
    s_cselect_b32 s61, 0, s61
    s_mul_i32 s64, s18, 5120
    s_add_u32 s64, s64, 81920
    v_lshl_add_u32 v243, v2, 4, s64
    s_xor_b32 s65, s18, 1
    s_mul_i32 s65, s65, 5120
    s_add_u32 s65, s65, 81920
    v_lshl_add_u32 v244, v2, 4, s65
    v_xor_b32 v252, v252, v221
    v_xor_b32 v253, v253, v221
    v_xor_b32 v236, v236, v221
    v_xor_b32 v237, v237, v221
    s_mul_i32 s64, s18, 2816
    s_add_u32 s64, s64, 122880
    v_mul_u32_u24 v5, 176, v3
    v_lshlrev_b32 v6, 3, v4
    v_add3_u32 v245, v5, v6, s64
    s_lshl_b32 s65, s59, 6
    s_lshl_b32 s57, s63, 5
    s_add_u32 s65, s65, s57
    s_lshl_b32 s57, s62, 4
    s_add_u32 s65, s65, s57
    s_mul_i32 s65, s65, 1280
    s_lshl_b32 s57, s60, 7
    s_add_u32 s65, s65, s57
    v_lshrrev_b32 v6, 3, v2
    v_and_b32 v7, 7, v2
    v_lshlrev_b32 v7, 4, v7
pad_S_3:
    s_cbranch_execz S_ret
    v_mul_u32_u24 v5, 176, v6
    v_add3_u32 v246, v5, v7, s64
    v_mul_u32_u24 v5, 1280, v6
    v_add3_u32 v249, v5, v7, s65
    v_add_u32 v247, 1408, v246
    v_add_u32 v250, 10240, v249
    s_mul_i32 s57, s60, 96
    s_sub_u32 s65, s65, s57
    s_add_u32 s65, s65, 1024
    s_add_u32 s64, s64, 128
    v_lshrrev_b32 v6, 1, v2
    v_and_b32 v6, 15, v6
    v_and_b32 v7, 1, v2
    v_lshlrev_b32 v7, 4, v7
    v_mul_u32_u24 v5, 176, v6
    v_add3_u32 v248, v5, v7, s64
    v_mul_u32_u24 v5, 1280, v6
    v_add3_u32 v251, v5, v7, s65
F_C2b:
    s_mov_b64 exec, 0
    s_cmp_eq_u32 s18, 0
    s_cbranch_scc1 pad_T_0
    s_cmp_eq_u32 s18, 1
    s_cbranch_scc1 pad_T_2
    s_cmp_eq_u32 s18, 2
    s_cbranch_scc1 pad_T_4
    s_branch T_ret
T_ret:
    s_mov_b64 exec, -1
    s_barrier
    s_cmp_lt_u32 s53, 30
    s_cbranch_scc1 F_nogo
    s_movk_i32 s57, 10240
    s_movk_i32 s58, 20480
    buffer_load_dword v60, v13, s[32:35], 0 offen
    buffer_load_dword v61, v13, s[32:35], s57 offen
    buffer_load_dword v62, v13, s[32:35], s58 offen
    s_mov_b32 s70, 0
F_Hgo:
    s_sleep 2
    buffer_load_dwordx2 v[14:15], v9, s[40:43], 0 offen sc1
    s_add_u32 s70, s70, 1
    s_waitcnt vmcnt(0)
    v_cmp_ne_u64 vcc, v[14:15], v[18:19]
    s_nop 4
    s_cbranch_vccz F_nogo
    s_cmp_lt_u32 s70, 262144
    s_cbranch_scc1 F_Hgo
F_nogo:
    s_mov_b32 s70, 0
    s_branch F_poll1
F_poll:
    s_sleep 4
F_poll1:
    buffer_load_dwordx2 v[14:15], v252, s[40:43], 0 offen sc1
    buffer_load_dwordx2 v[16:17], v253, s[40:43], 0 offen sc1
    s_add_u32 s70, s70, 1
    s_cmp_lg_u32 s70, 1
    s_cbranch_scc1 F_nrd
    ds_read_b64_tr_b16 v[20:21], v238 offset:0
    ds_read_b64_tr_b16 v[22:23], v238 offset:1024
    ds_read_b64_tr_b16 v[24:25], v239 offset:0
    ds_read_b64_tr_b16 v[26:27], v239 offset:1024
    ds_read_b64_tr_b16 v[28:29], v240 offset:0
    ds_read_b64_tr_b16 v[30:31], v240 offset:1024
    ds_read_b64_tr_b16 v[32:33], v241 offset:0
    ds_read_b64_tr_b16 v[34:35], v241 offset:1024
    ds_read_b64_tr_b16 v[36:37], v242 offset:0
    ds_read_b64_tr_b16 v[38:39], v242 offset:256
    ds_read_b64_tr_b16 v[40:41], v238 offset:5120
    ds_read_b64_tr_b16 v[42:43], v238 offset:6144
    ds_read_b64_tr_b16 v[44:45], v239 offset:5120
    ds_read_b64_tr_b16 v[46:47], v239 offset:6144
    ds_read_b64_tr_b16 v[48:49], v240 offset:5120
    ds_read_b64_tr_b16 v[50:51], v240 offset:6144
    ds_read_b64_tr_b16 v[52:53], v241 offset:5120
    ds_read_b64_tr_b16 v[54:55], v241 offset:6144
    ds_read_b64_tr_b16 v[56:57], v242 offset:5120
    ds_read_b64_tr_b16 v[58:59], v242 offset:5376
    ds_read_b64_tr_b16 v[60:61], v238 offset:10240
    ds_read_b64_tr_b16 v[62:63], v238 offset:11264
    ds_read_b64_tr_b16 v[64:65], v239 offset:10240
    ds_read_b64_tr_b16 v[66:67], v239 offset:11264
    ds_read_b64_tr_b16 v[68:69], v240 offset:10240
    ds_read_b64_tr_b16 v[70:71], v240 offset:11264
    ds_read_b64_tr_b16 v[72:73], v241 offset:10240
    ds_read_b64_tr_b16 v[74:75], v241 offset:11264
    ds_read_b64_tr_b16 v[76:77], v242 offset:10240
    ds_read_b64_tr_b16 v[78:79], v242 offset:10496
    ds_read_b64_tr_b16 v[80:81], v238 offset:15360
    ds_read_b64_tr_b16 v[82:83], v238 offset:16384
    ds_read_b64_tr_b16 v[84:85], v239 offset:15360
    ds_read_b64_tr_b16 v[86:87], v239 offset:16384
    ds_read_b64_tr_b16 v[88:89], v240 offset:15360
    ds_read_b64_tr_b16 v[90:91], v240 offset:16384
    ds_read_b64_tr_b16 v[92:93], v241 offset:15360
    ds_read_b64_tr_b16 v[94:95], v241 offset:16384
    ds_read_b64_tr_b16 v[96:97], v242 offset:15360
    ds_read_b64_tr_b16 v[98:99], v242 offset:15616
    ds_read_b64_tr_b16 v[100:101], v238 offset:40960
    ds_read_b64_tr_b16 v[102:103], v238 offset:41984
    ds_read_b64_tr_b16 v[104:105], v239 offset:40960
    ds_read_b64_tr_b16 v[106:107], v239 offset:41984
    ds_read_b64_tr_b16 v[108:109], v240 offset:40960
    ds_read_b64_tr_b16 v[110:111], v240 offset:41984
    ds_read_b64_tr_b16 v[112:113], v241 offset:40960
    ds_read_b64_tr_b16 v[114:115], v241 offset:41984
    ds_read_b64_tr_b16 v[116:117], v242 offset:40960
    ds_read_b64_tr_b16 v[118:119], v242 offset:41216
    ds_read_b64_tr_b16 v[120:121], v238 offset:46080
    ds_read_b64_tr_b16 v[122:123], v238 offset:47104
    ds_read_b64_tr_b16 v[124:125], v239 offset:46080
    ds_read_b64_tr_b16 v[126:127], v239 offset:47104
    ds_read_b64_tr_b16 v[128:129], v240 offset:46080
    ds_read_b64_tr_b16 v[130:131], v240 offset:47104
    ds_read_b64_tr_b16 v[132:133], v241 offset:46080
    ds_read_b64_tr_b16 v[134:135], v241 offset:47104
    ds_read_b64_tr_b16 v[136:137], v242 offset:46080
    ds_read_b64_tr_b16 v[138:139], v242 offset:46336
    ds_read_b64_tr_b16 v[140:141], v238 offset:51200
    ds_read_b64_tr_b16 v[142:143], v238 offset:52224
    ds_read_b64_tr_b16 v[144:145], v239 offset:51200
    ds_read_b64_tr_b16 v[146:147], v239 offset:52224
    ds_read_b64_tr_b16 v[148:149], v240 offset:51200
    ds_read_b64_tr_b16 v[150:151], v240 offset:52224
    ds_read_b64_tr_b16 v[152:153], v241 offset:51200
    ds_read_b64_tr_b16 v[154:155], v241 offset:52224
    ds_read_b64_tr_b16 v[156:157], v242 offset:51200
    ds_read_b64_tr_b16 v[158:159], v242 offset:51456
    ds_read_b64_tr_b16 v[160:161], v238 offset:56320
    ds_read_b64_tr_b16 v[162:163], v238 offset:57344
    ds_read_b64_tr_b16 v[164:165], v239 offset:56320
    ds_read_b64_tr_b16 v[166:167], v239 offset:57344
    ds_read_b64_tr_b16 v[168:169], v240 offset:56320
    ds_read_b64_tr_b16 v[170:171], v240 offset:57344
    ds_read_b64_tr_b16 v[172:173], v241 offset:56320
    ds_read_b64_tr_b16 v[174:175], v241 offset:57344
    ds_read_b64_tr_b16 v[176:177], v242 offset:56320
    ds_read_b64_tr_b16 v[178:179], v242 offset:56576
F_nrd:
    s_waitcnt vmcnt(0)
    v_cmp_ne_u64 vcc, v[14:15], v[18:19]
    v_cmp_ne_u64 s[64:65], v[16:17], v[18:19]
    s_nop 3
    s_or_b64 s[64:65], s[64:65], vcc
    s_cbranch_scc0 F_poll_ok
    s_cmp_lt_u32 s70, 262144
    s_cbranch_scc1 F_poll
F_poll_ok:
    buffer_load_dwordx4 v[220:223], v236, s[40:43], s96 offen offset:0 sc1
    buffer_load_dwordx4 v[224:227], v237, s[40:43], s96 offen offset:0 sc1
    buffer_load_dwordx4 v[228:231], v236, s[40:43], s96 offen offset:1024 sc1
    buffer_load_dwordx4 v[232:235], v237, s[40:43], s96 offen offset:1024 sc1
    buffer_load_dwordx4 v[4:7], v236, s[40:43], s96 offen offset:2048 sc1
    buffer_load_dwordx4 v[8:11], v237, s[40:43], s96 offen offset:2048 sc1
pad_T_0:
    s_cbranch_execz pad_T_1
    buffer_load_dwordx4 v[12:15], v236, s[40:43], s96 offen offset:3072 sc1
    buffer_load_dwordx4 v[16:19], v237, s[40:43], s96 offen offset:3072 sc1
    s_waitcnt lgkmcnt(0)
    s_barrier
    s_waitcnt vmcnt(6)
    v_mfma_f32_16x16x32_bf16 v[180:183], v[20:23], v[220:223], 0
    v_mfma_f32_16x16x32_bf16 v[200:203], v[20:23], v[224:227], 0
    v_mfma_f32_16x16x32_bf16 v[204:207], v[24:27], v[224:227], 0
    v_mfma_f32_16x16x32_bf16 v[184:187], v[24:27], v[220:223], 0
    v_mfma_f32_16x16x32_bf16 v[188:191], v[28:31], v[220:223], 0
    v_mfma_f32_16x16x32_bf16 v[208:211], v[28:31], v[224:227], 0
    v_mfma_f32_16x16x32_bf16 v[212:215], v[32:35], v[224:227], 0
    v_mfma_f32_16x16x32_bf16 v[192:195], v[32:35], v[220:223], 0
    v_mfma_f32_16x16x32_bf16 v[196:199], v[36:39], v[220:223], 0
    v_mfma_f32_16x16x32_bf16 v[216:219], v[36:39], v[224:227], 0
    s_waitcnt vmcnt(4)
    v_mfma_f32_16x16x32_bf16 v[180:183], v[40:43], v[228:231], v[180:183]
    v_mfma_f32_16x16x32_bf16 v[200:203], v[40:43], v[232:235], v[200:203]
    buffer_load_dwordx4 v[20:23], v236, s[40:43], s97 offen offset:0 sc1
    v_mfma_f32_16x16x32_bf16 v[204:207], v[44:47], v[232:235], v[204:207]
    v_mfma_f32_16x16x32_bf16 v[184:187], v[44:47], v[228:231], v[184:187]
    buffer_load_dwordx4 v[24:27], v237, s[40:43], s97 offen offset:0 sc1
    v_mfma_f32_16x16x32_bf16 v[188:191], v[48:51], v[228:231], v[188:191]
    v_mfma_f32_16x16x32_bf16 v[208:211], v[48:51], v[232:235], v[208:211]
    buffer_load_dwordx4 v[28:31], v236, s[40:43], s97 offen offset:1024 sc1
    v_mfma_f32_16x16x32_bf16 v[212:215], v[52:55], v[232:235], v[212:215]
    v_mfma_f32_16x16x32_bf16 v[192:195], v[52:55], v[228:231], v[192:195]
    buffer_load_dwordx4 v[32:35], v237, s[40:43], s97 offen offset:1024 sc1
    v_mfma_f32_16x16x32_bf16 v[196:199], v[56:59], v[228:231], v[196:199]
    v_mfma_f32_16x16x32_bf16 v[216:219], v[56:59], v[232:235], v[216:219]
    s_waitcnt vmcnt(6)
    v_mfma_f32_16x16x32_bf16 v[180:183], v[60:63], v[4:7], v[180:183]
    v_mfma_f32_16x16x32_bf16 v[200:203], v[60:63], v[8:11], v[200:203]
    buffer_load_dwordx4 v[36:39], v236, s[40:43], s97 offen offset:2048 sc1
    v_mfma_f32_16x16x32_bf16 v[204:207], v[64:67], v[8:11], v[204:207]
    v_mfma_f32_16x16x32_bf16 v[184:187], v[64:67], v[4:7], v[184:187]
    buffer_load_dwordx4 v[220:223], v237, s[40:43], s97 offen offset:2048 sc1
    v_mfma_f32_16x16x32_bf16 v[188:191], v[68:71], v[4:7], v[188:191]
    v_mfma_f32_16x16x32_bf16 v[208:211], v[68:71], v[8:11], v[208:211]
    buffer_load_dwordx4 v[224:227], v236, s[40:43], s97 offen offset:3072 sc1
    v_mfma_f32_16x16x32_bf16 v[212:215], v[72:75], v[8:11], v[212:215]
    v_mfma_f32_16x16x32_bf16 v[192:195], v[72:75], v[4:7], v[192:195]
    buffer_load_dwordx4 v[40:43], v237, s[40:43], s97 offen offset:3072 sc1
    v_mfma_f32_16x16x32_bf16 v[196:199], v[76:79], v[4:7], v[196:199]
    v_mfma_f32_16x16x32_bf16 v[216:219], v[76:79], v[8:11], v[216:219]
    s_waitcnt vmcnt(8)
    v_mfma_f32_16x16x32_bf16 v[180:183], v[80:83], v[12:15], v[180:183]
    v_mfma_f32_16x16x32_bf16 v[200:203], v[80:83], v[16:19], v[200:203]
    v_mfma_f32_16x16x32_bf16 v[204:207], v[84:87], v[16:19], v[204:207]
    v_mfma_f32_16x16x32_bf16 v[184:187], v[84:87], v[12:15], v[184:187]
    buffer_load_dwordx4 v[44:47], v236, s[40:43], s98 offen offset:0 sc1
    v_mfma_f32_16x16x32_bf16 v[188:191], v[88:91], v[12:15], v[188:191]
    v_mfma_f32_16x16x32_bf16 v[208:211], v[88:91], v[16:19], v[208:211]
    v_mfma_f32_16x16x32_bf16 v[212:215], v[92:95], v[16:19], v[212:215]
    v_mfma_f32_16x16x32_bf16 v[192:195], v[92:95], v[12:15], v[192:195]
    buffer_load_dwordx4 v[48:51], v237, s[40:43], s98 offen offset:0 sc1
    v_mfma_f32_16x16x32_bf16 v[196:199], v[96:99], v[12:15], v[196:199]
    v_mfma_f32_16x16x32_bf16 v[216:219], v[96:99], v[16:19], v[216:219]
    s_waitcnt vmcnt(8)
    v_mfma_f32_16x16x32_bf16 v[180:183], v[100:103], v[20:23], v[180:183]
    v_mfma_f32_16x16x32_bf16 v[200:203], v[100:103], v[24:27], v[200:203]
    v_mfma_f32_16x16x32_bf16 v[204:207], v[104:107], v[24:27], v[204:207]
    v_mfma_f32_16x16x32_bf16 v[184:187], v[104:107], v[20:23], v[184:187]
    buffer_load_dwordx4 v[52:55], v236, s[40:43], s98 offen offset:1024 sc1
    v_mfma_f32_16x16x32_bf16 v[188:191], v[108:111], v[20:23], v[188:191]
    v_mfma_f32_16x16x32_bf16 v[208:211], v[108:111], v[24:27], v[208:211]
    v_mfma_f32_16x16x32_bf16 v[212:215], v[112:115], v[24:27], v[212:215]
    v_mfma_f32_16x16x32_bf16 v[192:195], v[112:115], v[20:23], v[192:195]
    buffer_load_dwordx4 v[56:59], v237, s[40:43], s98 offen offset:1024 sc1
    v_mfma_f32_16x16x32_bf16 v[196:199], v[116:119], v[20:23], v[196:199]
    v_mfma_f32_16x16x32_bf16 v[216:219], v[116:119], v[24:27], v[216:219]
    s_waitcnt vmcnt(8)
    v_mfma_f32_16x16x32_bf16 v[180:183], v[120:123], v[28:31], v[180:183]
    v_mfma_f32_16x16x32_bf16 v[200:203], v[120:123], v[32:35], v[200:203]
    v_mfma_f32_16x16x32_bf16 v[204:207], v[124:127], v[32:35], v[204:207]
    v_mfma_f32_16x16x32_bf16 v[184:187], v[124:127], v[28:31], v[184:187]
    buffer_load_dwordx4 v[228:231], v236, s[40:43], s98 offen offset:2048 sc1
    v_mfma_f32_16x16x32_bf16 v[188:191], v[128:131], v[28:31], v[188:191]
    v_mfma_f32_16x16x32_bf16 v[208:211], v[128:131], v[32:35], v[208:211]
    v_mfma_f32_16x16x32_bf16 v[212:215], v[132:135], v[32:35], v[212:215]
    v_mfma_f32_16x16x32_bf16 v[192:195], v[132:135], v[28:31], v[192:195]
    buffer_load_dwordx4 v[232:235], v237, s[40:43], s98 offen offset:2048 sc1
    v_mfma_f32_16x16x32_bf16 v[196:199], v[136:139], v[28:31], v[196:199]
    v_mfma_f32_16x16x32_bf16 v[216:219], v[136:139], v[32:35], v[216:219]
    s_waitcnt vmcnt(8)
    v_mfma_f32_16x16x32_bf16 v[180:183], v[140:143], v[36:39], v[180:183]
    v_add_u32 v238, 0x14000, v238
    ds_read_b64_tr_b16 v[60:61], v238 offset:0
    v_mfma_f32_16x16x32_bf16 v[200:203], v[140:143], v[220:223], v[200:203]
    ds_read_b64_tr_b16 v[62:63], v238 offset:1024
    v_mfma_f32_16x16x32_bf16 v[204:207], v[144:147], v[220:223], v[204:207]
    v_add_u32 v239, 0x14000, v239
    ds_read_b64_tr_b16 v[64:65], v239 offset:0
    v_mfma_f32_16x16x32_bf16 v[184:187], v[144:147], v[36:39], v[184:187]
    ds_read_b64_tr_b16 v[66:67], v239 offset:1024
    buffer_load_dwordx4 v[4:7], v236, s[40:43], s98 offen offset:3072 sc1
    v_mfma_f32_16x16x32_bf16 v[188:191], v[148:151], v[36:39], v[188:191]
    v_add_u32 v240, 0x14000, v240
    ds_read_b64_tr_b16 v[68:69], v240 offset:0
    v_mfma_f32_16x16x32_bf16 v[208:211], v[148:151], v[220:223], v[208:211]
    ds_read_b64_tr_b16 v[70:71], v240 offset:1024
    v_mfma_f32_16x16x32_bf16 v[212:215], v[152:155], v[220:223], v[212:215]
    v_add_u32 v241, 0x14000, v241
    ds_read_b64_tr_b16 v[72:73], v241 offset:0
    v_mfma_f32_16x16x32_bf16 v[192:195], v[152:155], v[36:39], v[192:195]
    ds_read_b64_tr_b16 v[74:75], v241 offset:1024
    buffer_load_dwordx4 v[8:11], v237, s[40:43], s98 offen offset:3072 sc1
    v_mfma_f32_16x16x32_bf16 v[196:199], v[156:159], v[36:39], v[196:199]
    v_add_u32 v242, 0x14000, v242
    ds_read_b64_tr_b16 v[76:77], v242 offset:0
    v_mfma_f32_16x16x32_bf16 v[216:219], v[156:159], v[220:223], v[216:219]
    ds_read_b64_tr_b16 v[78:79], v242 offset:256
    s_waitcnt vmcnt(8)
    v_mfma_f32_16x16x32_bf16 v[180:183], v[160:163], v[224:227], v[180:183]
    ds_read_b64_tr_b16 v[80:81], v238 offset:5120
    v_mfma_f32_16x16x32_bf16 v[200:203], v[160:163], v[40:43], v[200:203]
    ds_read_b64_tr_b16 v[82:83], v238 offset:6144
    v_mfma_f32_16x16x32_bf16 v[204:207], v[164:167], v[40:43], v[204:207]
    ds_read_b64_tr_b16 v[84:85], v239 offset:5120
    v_mfma_f32_16x16x32_bf16 v[184:187], v[164:167], v[224:227], v[184:187]
    ds_read_b64_tr_b16 v[86:87], v239 offset:6144
    buffer_load_dwordx4 v[12:15], v236, s[40:43], s99 offen offset:0 sc1
    v_mfma_f32_16x16x32_bf16 v[188:191], v[168:171], v[224:227], v[188:191]
    ds_read_b64_tr_b16 v[88:89], v240 offset:5120
    v_mfma_f32_16x16x32_bf16 v[208:211], v[168:171], v[40:43], v[208:211]
    ds_read_b64_tr_b16 v[90:91], v240 offset:6144
    v_mfma_f32_16x16x32_bf16 v[212:215], v[172:175], v[40:43], v[212:215]
    ds_read_b64_tr_b16 v[92:93], v241 offset:5120
    v_mfma_f32_16x16x32_bf16 v[192:195], v[172:175], v[224:227], v[192:195]
    ds_read_b64_tr_b16 v[94:95], v241 offset:6144
    buffer_load_dwordx4 v[16:19], v237, s[40:43], s99 offen offset:0 sc1
    v_mfma_f32_16x16x32_bf16 v[196:199], v[176:179], v[224:227], v[196:199]
    ds_read_b64_tr_b16 v[96:97], v242 offset:5120
pad_T_1:
    s_cbranch_execz T_ret
    v_mfma_f32_16x16x32_bf16 v[216:219], v[176:179], v[40:43], v[216:219]
    ds_read_b64_tr_b16 v[98:99], v242 offset:5376
    s_waitcnt vmcnt(8) lgkmcnt(10)
    v_mfma_f32_16x16x32_bf16 v[180:183], v[60:63], v[44:47], v[180:183]
    ds_read_b64_tr_b16 v[100:101], v238 offset:10240
    v_mfma_f32_16x16x32_bf16 v[200:203], v[60:63], v[48:51], v[200:203]
    ds_read_b64_tr_b16 v[102:103], v238 offset:11264
    v_mfma_f32_16x16x32_bf16 v[204:207], v[64:67], v[48:51], v[204:207]
    ds_read_b64_tr_b16 v[104:105], v239 offset:10240
    v_mfma_f32_16x16x32_bf16 v[184:187], v[64:67], v[44:47], v[184:187]
    ds_read_b64_tr_b16 v[106:107], v239 offset:11264
    buffer_load_dwordx4 v[20:23], v236, s[40:43], s99 offen offset:1024 sc1
    v_mfma_f32_16x16x32_bf16 v[188:191], v[68:71], v[44:47], v[188:191]
    ds_read_b64_tr_b16 v[108:109], v240 offset:10240
    v_mfma_f32_16x16x32_bf16 v[208:211], v[68:71], v[48:51], v[208:211]
    ds_read_b64_tr_b16 v[110:111], v240 offset:11264
    v_mfma_f32_16x16x32_bf16 v[212:215], v[72:75], v[48:51], v[212:215]
    ds_read_b64_tr_b16 v[112:113], v241 offset:10240
    v_mfma_f32_16x16x32_bf16 v[192:195], v[72:75], v[44:47], v[192:195]
    ds_read_b64_tr_b16 v[114:115], v241 offset:11264
    buffer_load_dwordx4 v[24:27], v237, s[40:43], s99 offen offset:1024 sc1
    v_mfma_f32_16x16x32_bf16 v[196:199], v[76:79], v[44:47], v[196:199]
    ds_read_b64_tr_b16 v[116:117], v242 offset:10240
    v_mfma_f32_16x16x32_bf16 v[216:219], v[76:79], v[48:51], v[216:219]
    ds_read_b64_tr_b16 v[118:119], v242 offset:10496
    s_waitcnt vmcnt(8) lgkmcnt(10)
    v_mfma_f32_16x16x32_bf16 v[180:183], v[80:83], v[52:55], v[180:183]
    ds_read_b64_tr_b16 v[120:121], v238 offset:15360
    v_mfma_f32_16x16x32_bf16 v[200:203], v[80:83], v[56:59], v[200:203]
    ds_read_b64_tr_b16 v[122:123], v238 offset:16384
    v_mfma_f32_16x16x32_bf16 v[204:207], v[84:87], v[56:59], v[204:207]
    ds_read_b64_tr_b16 v[124:125], v239 offset:15360
    v_mfma_f32_16x16x32_bf16 v[184:187], v[84:87], v[52:55], v[184:187]
    ds_read_b64_tr_b16 v[126:127], v239 offset:16384
    buffer_load_dwordx4 v[28:31], v236, s[40:43], s99 offen offset:2048 sc1
    v_mfma_f32_16x16x32_bf16 v[188:191], v[88:91], v[52:55], v[188:191]
    ds_read_b64_tr_b16 v[128:129], v240 offset:15360
    v_mfma_f32_16x16x32_bf16 v[208:211], v[88:91], v[56:59], v[208:211]
    ds_read_b64_tr_b16 v[130:131], v240 offset:16384
    v_mfma_f32_16x16x32_bf16 v[212:215], v[92:95], v[56:59], v[212:215]
    ds_read_b64_tr_b16 v[132:133], v241 offset:15360
    v_mfma_f32_16x16x32_bf16 v[192:195], v[92:95], v[52:55], v[192:195]
    ds_read_b64_tr_b16 v[134:135], v241 offset:16384
    buffer_load_dwordx4 v[32:35], v237, s[40:43], s99 offen offset:2048 sc1
    v_mfma_f32_16x16x32_bf16 v[196:199], v[96:99], v[52:55], v[196:199]
    ds_read_b64_tr_b16 v[136:137], v242 offset:15360
    v_mfma_f32_16x16x32_bf16 v[216:219], v[96:99], v[56:59], v[216:219]
    ds_read_b64_tr_b16 v[138:139], v242 offset:15616
    s_waitcnt vmcnt(8) lgkmcnt(10)
    s_barrier
    v_mfma_f32_16x16x32_bf16 v[180:183], v[100:103], v[228:231], v[180:183]
    ds_read_b64_tr_b16 v[140:141], v238 offset:40960
    v_mfma_f32_16x16x32_bf16 v[200:203], v[100:103], v[232:235], v[200:203]
    ds_read_b64_tr_b16 v[142:143], v238 offset:41984
    v_mfma_f32_16x16x32_bf16 v[204:207], v[104:107], v[232:235], v[204:207]
    ds_read_b64_tr_b16 v[144:145], v239 offset:40960
    v_mfma_f32_16x16x32_bf16 v[184:187], v[104:107], v[228:231], v[184:187]
    ds_read_b64_tr_b16 v[146:147], v239 offset:41984
    buffer_load_dwordx4 v[36:39], v236, s[40:43], s99 offen offset:3072 sc1
    v_mfma_f32_16x16x32_bf16 v[188:191], v[108:111], v[228:231], v[188:191]
    ds_read_b64_tr_b16 v[148:149], v240 offset:40960
    v_mfma_f32_16x16x32_bf16 v[208:211], v[108:111], v[232:235], v[208:211]
    ds_read_b64_tr_b16 v[150:151], v240 offset:41984
    v_mfma_f32_16x16x32_bf16 v[212:215], v[112:115], v[232:235], v[212:215]
    ds_read_b64_tr_b16 v[152:153], v241 offset:40960
    v_mfma_f32_16x16x32_bf16 v[192:195], v[112:115], v[228:231], v[192:195]
    ds_read_b64_tr_b16 v[154:155], v241 offset:41984
    buffer_load_dwordx4 v[220:223], v237, s[40:43], s99 offen offset:3072 sc1
    v_mfma_f32_16x16x32_bf16 v[196:199], v[116:119], v[228:231], v[196:199]
    ds_read_b64_tr_b16 v[156:157], v242 offset:40960
    v_mfma_f32_16x16x32_bf16 v[216:219], v[116:119], v[232:235], v[216:219]
    ds_read_b64_tr_b16 v[158:159], v242 offset:41216
    s_waitcnt vmcnt(8) lgkmcnt(10)
    v_mfma_f32_16x16x32_bf16 v[180:183], v[120:123], v[4:7], v[180:183]
    ds_read_b64_tr_b16 v[160:161], v238 offset:46080
    v_mfma_f32_16x16x32_bf16 v[200:203], v[120:123], v[8:11], v[200:203]
    ds_read_b64_tr_b16 v[162:163], v238 offset:47104
    v_mfma_f32_16x16x32_bf16 v[204:207], v[124:127], v[8:11], v[204:207]
    ds_read_b64_tr_b16 v[164:165], v239 offset:46080
    v_mfma_f32_16x16x32_bf16 v[184:187], v[124:127], v[4:7], v[184:187]
    ds_read_b64_tr_b16 v[166:167], v239 offset:47104
    buffer_load_dwordx4 v[224:227], v236, s[40:43], s100 offen offset:0 sc1
    v_mfma_f32_16x16x32_bf16 v[188:191], v[128:131], v[4:7], v[188:191]
    ds_read_b64_tr_b16 v[168:169], v240 offset:46080
    v_mfma_f32_16x16x32_bf16 v[208:211], v[128:131], v[8:11], v[208:211]
    ds_read_b64_tr_b16 v[170:171], v240 offset:47104
    v_mfma_f32_16x16x32_bf16 v[212:215], v[132:135], v[8:11], v[212:215]
    ds_read_b64_tr_b16 v[172:173], v241 offset:46080
    v_mfma_f32_16x16x32_bf16 v[192:195], v[132:135], v[4:7], v[192:195]
    ds_read_b64_tr_b16 v[174:175], v241 offset:47104
    buffer_load_dwordx4 v[40:43], v237, s[40:43], s100 offen offset:0 sc1
    v_mfma_f32_16x16x32_bf16 v[196:199], v[136:139], v[4:7], v[196:199]
    ds_read_b64_tr_b16 v[176:177], v242 offset:46080
    v_mfma_f32_16x16x32_bf16 v[216:219], v[136:139], v[8:11], v[216:219]
    ds_read_b64_tr_b16 v[178:179], v242 offset:46336
    s_waitcnt vmcnt(8) lgkmcnt(10)
    v_mfma_f32_16x16x32_bf16 v[180:183], v[140:143], v[12:15], v[180:183]
    ds_read_b64_tr_b16 v[60:61], v238 offset:51200
    v_mfma_f32_16x16x32_bf16 v[200:203], v[140:143], v[16:19], v[200:203]
    ds_read_b64_tr_b16 v[62:63], v238 offset:52224
    v_mfma_f32_16x16x32_bf16 v[204:207], v[144:147], v[16:19], v[204:207]
    ds_read_b64_tr_b16 v[64:65], v239 offset:51200
    v_mfma_f32_16x16x32_bf16 v[184:187], v[144:147], v[12:15], v[184:187]
    ds_read_b64_tr_b16 v[66:67], v239 offset:52224
    buffer_load_dwordx4 v[44:47], v236, s[40:43], s100 offen offset:1024 sc1
    v_mfma_f32_16x16x32_bf16 v[188:191], v[148:151], v[12:15], v[188:191]
    ds_read_b64_tr_b16 v[68:69], v240 offset:51200
    v_mfma_f32_16x16x32_bf16 v[208:211], v[148:151], v[16:19], v[208:211]
    ds_read_b64_tr_b16 v[70:71], v240 offset:52224
    v_mfma_f32_16x16x32_bf16 v[212:215], v[152:155], v[16:19], v[212:215]
    ds_read_b64_tr_b16 v[72:73], v241 offset:51200
    v_mfma_f32_16x16x32_bf16 v[192:195], v[152:155], v[12:15], v[192:195]
    ds_read_b64_tr_b16 v[74:75], v241 offset:52224
    buffer_load_dwordx4 v[48:51], v237, s[40:43], s100 offen offset:1024 sc1
    v_mfma_f32_16x16x32_bf16 v[196:199], v[156:159], v[12:15], v[196:199]
    ds_read_b64_tr_b16 v[76:77], v242 offset:51200
    v_mfma_f32_16x16x32_bf16 v[216:219], v[156:159], v[16:19], v[216:219]
    ds_read_b64_tr_b16 v[78:79], v242 offset:51456
    s_waitcnt vmcnt(8) lgkmcnt(10)
    v_mfma_f32_16x16x32_bf16 v[180:183], v[160:163], v[20:23], v[180:183]
    ds_read_b64_tr_b16 v[80:81], v238 offset:56320
    v_mfma_f32_16x16x32_bf16 v[200:203], v[160:163], v[24:27], v[200:203]
    ds_read_b64_tr_b16 v[82:83], v238 offset:57344
    v_mfma_f32_16x16x32_bf16 v[204:207], v[164:167], v[24:27], v[204:207]
    ds_read_b64_tr_b16 v[84:85], v239 offset:56320
    v_mfma_f32_16x16x32_bf16 v[184:187], v[164:167], v[20:23], v[184:187]
    ds_read_b64_tr_b16 v[86:87], v239 offset:57344
    buffer_load_dwordx4 v[52:55], v236, s[40:43], s100 offen offset:2048 sc1
    v_mfma_f32_16x16x32_bf16 v[188:191], v[168:171], v[20:23], v[188:191]
    ds_read_b64_tr_b16 v[88:89], v240 offset:56320
    v_mfma_f32_16x16x32_bf16 v[208:211], v[168:171], v[24:27], v[208:211]
pad_T_2:
    s_cbranch_execz pad_T_3
    ds_read_b64_tr_b16 v[90:91], v240 offset:57344
    v_mfma_f32_16x16x32_bf16 v[212:215], v[172:175], v[24:27], v[212:215]
    ds_read_b64_tr_b16 v[92:93], v241 offset:56320
    v_mfma_f32_16x16x32_bf16 v[192:195], v[172:175], v[20:23], v[192:195]
    ds_read_b64_tr_b16 v[94:95], v241 offset:57344
    buffer_load_dwordx4 v[56:59], v237, s[40:43], s100 offen offset:2048 sc1
    v_mfma_f32_16x16x32_bf16 v[196:199], v[176:179], v[20:23], v[196:199]
    ds_read_b64_tr_b16 v[96:97], v242 offset:56320
    v_mfma_f32_16x16x32_bf16 v[216:219], v[176:179], v[24:27], v[216:219]
    ds_read_b64_tr_b16 v[98:99], v242 offset:56576
    s_waitcnt vmcnt(8) lgkmcnt(10)
    v_mfma_f32_16x16x32_bf16 v[180:183], v[60:63], v[28:31], v[180:183]
    v_add_u32 v238, 0xfffec000, v238
    ds_read_b64_tr_b16 v[100:101], v238 offset:0
    v_mfma_f32_16x16x32_bf16 v[200:203], v[60:63], v[32:35], v[200:203]
    ds_read_b64_tr_b16 v[102:103], v238 offset:1024
    v_mfma_f32_16x16x32_bf16 v[204:207], v[64:67], v[32:35], v[204:207]
    v_add_u32 v239, 0xfffec000, v239
    ds_read_b64_tr_b16 v[104:105], v239 offset:0
    v_mfma_f32_16x16x32_bf16 v[184:187], v[64:67], v[28:31], v[184:187]
    ds_read_b64_tr_b16 v[106:107], v239 offset:1024
    buffer_load_dwordx4 v[228:231], v236, s[40:43], s100 offen offset:3072 sc1
    v_mfma_f32_16x16x32_bf16 v[188:191], v[68:71], v[28:31], v[188:191]
    v_add_u32 v240, 0xfffec000, v240
    ds_read_b64_tr_b16 v[108:109], v240 offset:0
    v_mfma_f32_16x16x32_bf16 v[208:211], v[68:71], v[32:35], v[208:211]
    ds_read_b64_tr_b16 v[110:111], v240 offset:1024
    v_mfma_f32_16x16x32_bf16 v[212:215], v[72:75], v[32:35], v[212:215]
    v_add_u32 v241, 0xfffec000, v241
    ds_read_b64_tr_b16 v[112:113], v241 offset:0
    v_mfma_f32_16x16x32_bf16 v[192:195], v[72:75], v[28:31], v[192:195]
    ds_read_b64_tr_b16 v[114:115], v241 offset:1024
    buffer_load_dwordx4 v[232:235], v237, s[40:43], s100 offen offset:3072 sc1
    v_mfma_f32_16x16x32_bf16 v[196:199], v[76:79], v[28:31], v[196:199]
    v_add_u32 v242, 0xfffec000, v242
    ds_read_b64_tr_b16 v[116:117], v242 offset:0
    v_mfma_f32_16x16x32_bf16 v[216:219], v[76:79], v[32:35], v[216:219]
    ds_read_b64_tr_b16 v[118:119], v242 offset:256
    s_waitcnt vmcnt(8) lgkmcnt(10)
    s_barrier
    v_mfma_f32_16x16x32_bf16 v[180:183], v[80:83], v[36:39], v[180:183]
    ds_read_b64_tr_b16 v[120:121], v238 offset:5120
    v_mfma_f32_16x16x32_bf16 v[200:203], v[80:83], v[220:223], v[200:203]
    ds_read_b64_tr_b16 v[122:123], v238 offset:6144
    v_mfma_f32_16x16x32_bf16 v[204:207], v[84:87], v[220:223], v[204:207]
    ds_read_b64_tr_b16 v[124:125], v239 offset:5120
    v_mfma_f32_16x16x32_bf16 v[184:187], v[84:87], v[36:39], v[184:187]
    ds_read_b64_tr_b16 v[126:127], v239 offset:6144
    buffer_load_dwordx4 v[4:7], v236, s[40:43], s101 offen offset:0 sc1
    v_mfma_f32_16x16x32_bf16 v[188:191], v[88:91], v[36:39], v[188:191]
    ds_read_b64_tr_b16 v[128:129], v240 offset:5120
    v_mfma_f32_16x16x32_bf16 v[208:211], v[88:91], v[220:223], v[208:211]
    ds_read_b64_tr_b16 v[130:131], v240 offset:6144
    v_mfma_f32_16x16x32_bf16 v[212:215], v[92:95], v[220:223], v[212:215]
    ds_read_b64_tr_b16 v[132:133], v241 offset:5120
    v_mfma_f32_16x16x32_bf16 v[192:195], v[92:95], v[36:39], v[192:195]
    ds_read_b64_tr_b16 v[134:135], v241 offset:6144
    buffer_load_dwordx4 v[8:11], v237, s[40:43], s101 offen offset:0 sc1
    v_mfma_f32_16x16x32_bf16 v[196:199], v[96:99], v[36:39], v[196:199]
    ds_read_b64_tr_b16 v[136:137], v242 offset:5120
    v_mfma_f32_16x16x32_bf16 v[216:219], v[96:99], v[220:223], v[216:219]
    ds_read_b64_tr_b16 v[138:139], v242 offset:5376
    s_waitcnt vmcnt(8) lgkmcnt(10)
    v_mfma_f32_16x16x32_bf16 v[180:183], v[100:103], v[224:227], v[180:183]
    ds_read_b64_tr_b16 v[140:141], v238 offset:10240
    v_mfma_f32_16x16x32_bf16 v[200:203], v[100:103], v[40:43], v[200:203]
    ds_read_b64_tr_b16 v[142:143], v238 offset:11264
    v_mfma_f32_16x16x32_bf16 v[204:207], v[104:107], v[40:43], v[204:207]
    ds_read_b64_tr_b16 v[144:145], v239 offset:10240
    v_mfma_f32_16x16x32_bf16 v[184:187], v[104:107], v[224:227], v[184:187]
    ds_read_b64_tr_b16 v[146:147], v239 offset:11264
    buffer_load_dwordx4 v[12:15], v236, s[40:43], s101 offen offset:1024 sc1
    v_mfma_f32_16x16x32_bf16 v[188:191], v[108:111], v[224:227], v[188:191]
    ds_read_b64_tr_b16 v[148:149], v240 offset:10240
    v_mfma_f32_16x16x32_bf16 v[208:211], v[108:111], v[40:43], v[208:211]
    ds_read_b64_tr_b16 v[150:151], v240 offset:11264
    v_mfma_f32_16x16x32_bf16 v[212:215], v[112:115], v[40:43], v[212:215]
    ds_read_b64_tr_b16 v[152:153], v241 offset:10240
    v_mfma_f32_16x16x32_bf16 v[192:195], v[112:115], v[224:227], v[192:195]
    ds_read_b64_tr_b16 v[154:155], v241 offset:11264
    buffer_load_dwordx4 v[16:19], v237, s[40:43], s101 offen offset:1024 sc1
    v_mfma_f32_16x16x32_bf16 v[196:199], v[116:119], v[224:227], v[196:199]
    ds_read_b64_tr_b16 v[156:157], v242 offset:10240
    v_mfma_f32_16x16x32_bf16 v[216:219], v[116:119], v[40:43], v[216:219]
    ds_read_b64_tr_b16 v[158:159], v242 offset:10496
    s_waitcnt vmcnt(8) lgkmcnt(10)
    v_mfma_f32_16x16x32_bf16 v[180:183], v[120:123], v[44:47], v[180:183]
    ds_read_b64_tr_b16 v[160:161], v238 offset:15360
    v_mfma_f32_16x16x32_bf16 v[200:203], v[120:123], v[48:51], v[200:203]
    ds_read_b64_tr_b16 v[162:163], v238 offset:16384
    v_mfma_f32_16x16x32_bf16 v[204:207], v[124:127], v[48:51], v[204:207]
    ds_read_b64_tr_b16 v[164:165], v239 offset:15360
    v_mfma_f32_16x16x32_bf16 v[184:187], v[124:127], v[44:47], v[184:187]
    ds_read_b64_tr_b16 v[166:167], v239 offset:16384
    buffer_load_dwordx4 v[20:23], v236, s[40:43], s101 offen offset:2048 sc1
    v_mfma_f32_16x16x32_bf16 v[188:191], v[128:131], v[44:47], v[188:191]
    ds_read_b64_tr_b16 v[168:169], v240 offset:15360
    v_mfma_f32_16x16x32_bf16 v[208:211], v[128:131], v[48:51], v[208:211]
    ds_read_b64_tr_b16 v[170:171], v240 offset:16384
    v_mfma_f32_16x16x32_bf16 v[212:215], v[132:135], v[48:51], v[212:215]
    ds_read_b64_tr_b16 v[172:173], v241 offset:15360
    v_mfma_f32_16x16x32_bf16 v[192:195], v[132:135], v[44:47], v[192:195]
    ds_read_b64_tr_b16 v[174:175], v241 offset:16384
    buffer_load_dwordx4 v[24:27], v237, s[40:43], s101 offen offset:2048 sc1
    v_mfma_f32_16x16x32_bf16 v[196:199], v[136:139], v[44:47], v[196:199]
    ds_read_b64_tr_b16 v[176:177], v242 offset:15360
    v_mfma_f32_16x16x32_bf16 v[216:219], v[136:139], v[48:51], v[216:219]
    ds_read_b64_tr_b16 v[178:179], v242 offset:15616
    s_waitcnt vmcnt(8) lgkmcnt(10)
    v_mfma_f32_16x16x32_bf16 v[180:183], v[140:143], v[52:55], v[180:183]
    ds_read_b64_tr_b16 v[60:61], v238 offset:40960
    v_mfma_f32_16x16x32_bf16 v[200:203], v[140:143], v[56:59], v[200:203]
    ds_read_b64_tr_b16 v[62:63], v238 offset:41984
    v_mfma_f32_16x16x32_bf16 v[204:207], v[144:147], v[56:59], v[204:207]
    ds_read_b64_tr_b16 v[64:65], v239 offset:40960
    v_mfma_f32_16x16x32_bf16 v[184:187], v[144:147], v[52:55], v[184:187]
    ds_read_b64_tr_b16 v[66:67], v239 offset:41984
    buffer_load_dwordx4 v[28:31], v236, s[40:43], s101 offen offset:3072 sc1
    v_mfma_f32_16x16x32_bf16 v[188:191], v[148:151], v[52:55], v[188:191]
    ds_read_b64_tr_b16 v[68:69], v240 offset:40960
    v_mfma_f32_16x16x32_bf16 v[208:211], v[148:151], v[56:59], v[208:211]
    ds_read_b64_tr_b16 v[70:71], v240 offset:41984
    v_mfma_f32_16x16x32_bf16 v[212:215], v[152:155], v[56:59], v[212:215]
    ds_read_b64_tr_b16 v[72:73], v241 offset:40960
    v_mfma_f32_16x16x32_bf16 v[192:195], v[152:155], v[52:55], v[192:195]
    ds_read_b64_tr_b16 v[74:75], v241 offset:41984
    buffer_load_dwordx4 v[32:35], v237, s[40:43], s101 offen offset:3072 sc1
    v_mfma_f32_16x16x32_bf16 v[196:199], v[156:159], v[52:55], v[196:199]
    ds_read_b64_tr_b16 v[76:77], v242 offset:40960
    v_mfma_f32_16x16x32_bf16 v[216:219], v[156:159], v[56:59], v[216:219]
pad_T_3:
    s_cbranch_execz T_ret
    ds_read_b64_tr_b16 v[78:79], v242 offset:41216
    s_waitcnt vmcnt(8) lgkmcnt(10)
    v_mfma_f32_16x16x32_bf16 v[180:183], v[160:163], v[228:231], v[180:183]
    ds_read_b64_tr_b16 v[80:81], v238 offset:46080
    v_mfma_f32_16x16x32_bf16 v[200:203], v[160:163], v[232:235], v[200:203]
    ds_read_b64_tr_b16 v[82:83], v238 offset:47104
    v_mfma_f32_16x16x32_bf16 v[204:207], v[164:167], v[232:235], v[204:207]
    ds_read_b64_tr_b16 v[84:85], v239 offset:46080
    v_mfma_f32_16x16x32_bf16 v[184:187], v[164:167], v[228:231], v[184:187]
    ds_read_b64_tr_b16 v[86:87], v239 offset:47104
    v_mfma_f32_16x16x32_bf16 v[188:191], v[168:171], v[228:231], v[188:191]
    ds_read_b64_tr_b16 v[88:89], v240 offset:46080
    v_mfma_f32_16x16x32_bf16 v[208:211], v[168:171], v[232:235], v[208:211]
    ds_read_b64_tr_b16 v[90:91], v240 offset:47104
    v_mfma_f32_16x16x32_bf16 v[212:215], v[172:175], v[232:235], v[212:215]
    ds_read_b64_tr_b16 v[92:93], v241 offset:46080
    v_mfma_f32_16x16x32_bf16 v[192:195], v[172:175], v[228:231], v[192:195]
    ds_read_b64_tr_b16 v[94:95], v241 offset:47104
    v_mfma_f32_16x16x32_bf16 v[196:199], v[176:179], v[228:231], v[196:199]
    ds_read_b64_tr_b16 v[96:97], v242 offset:46080
    v_mfma_f32_16x16x32_bf16 v[216:219], v[176:179], v[232:235], v[216:219]
    ds_read_b64_tr_b16 v[98:99], v242 offset:46336
    s_waitcnt vmcnt(6) lgkmcnt(10)
    v_mfma_f32_16x16x32_bf16 v[180:183], v[60:63], v[4:7], v[180:183]
    ds_read_b64_tr_b16 v[36:37], v238 offset:51200
    v_mfma_f32_16x16x32_bf16 v[200:203], v[60:63], v[8:11], v[200:203]
    ds_read_b64_tr_b16 v[38:39], v238 offset:52224
    v_mfma_f32_16x16x32_bf16 v[204:207], v[64:67], v[8:11], v[204:207]
    ds_read_b64_tr_b16 v[220:221], v239 offset:51200
    v_mfma_f32_16x16x32_bf16 v[184:187], v[64:67], v[4:7], v[184:187]
    ds_read_b64_tr_b16 v[222:223], v239 offset:52224
    v_mfma_f32_16x16x32_bf16 v[188:191], v[68:71], v[4:7], v[188:191]
    ds_read_b64_tr_b16 v[100:101], v240 offset:51200
    v_mfma_f32_16x16x32_bf16 v[208:211], v[68:71], v[8:11], v[208:211]
    ds_read_b64_tr_b16 v[102:103], v240 offset:52224
    v_mfma_f32_16x16x32_bf16 v[212:215], v[72:75], v[8:11], v[212:215]
    ds_read_b64_tr_b16 v[104:105], v241 offset:51200
    v_mfma_f32_16x16x32_bf16 v[192:195], v[72:75], v[4:7], v[192:195]
    ds_read_b64_tr_b16 v[106:107], v241 offset:52224
    v_mfma_f32_16x16x32_bf16 v[196:199], v[76:79], v[4:7], v[196:199]
    ds_read_b64_tr_b16 v[108:109], v242 offset:51200
    v_mfma_f32_16x16x32_bf16 v[216:219], v[76:79], v[8:11], v[216:219]
    ds_read_b64_tr_b16 v[110:111], v242 offset:51456
    s_waitcnt vmcnt(4) lgkmcnt(10)
    v_mfma_f32_16x16x32_bf16 v[180:183], v[80:83], v[12:15], v[180:183]
    ds_read_b64_tr_b16 v[112:113], v238 offset:56320
    v_mfma_f32_16x16x32_bf16 v[200:203], v[80:83], v[16:19], v[200:203]
    ds_read_b64_tr_b16 v[114:115], v238 offset:57344
    v_mfma_f32_16x16x32_bf16 v[204:207], v[84:87], v[16:19], v[204:207]
    ds_read_b64_tr_b16 v[116:117], v239 offset:56320
    v_mfma_f32_16x16x32_bf16 v[184:187], v[84:87], v[12:15], v[184:187]
    ds_read_b64_tr_b16 v[118:119], v239 offset:57344
    v_mfma_f32_16x16x32_bf16 v[188:191], v[88:91], v[12:15], v[188:191]
    ds_read_b64_tr_b16 v[224:225], v240 offset:56320
    v_mfma_f32_16x16x32_bf16 v[208:211], v[88:91], v[16:19], v[208:211]
    ds_read_b64_tr_b16 v[226:227], v240 offset:57344
    v_mfma_f32_16x16x32_bf16 v[212:215], v[92:95], v[16:19], v[212:215]
    ds_read_b64_tr_b16 v[40:41], v241 offset:56320
    v_mfma_f32_16x16x32_bf16 v[192:195], v[92:95], v[12:15], v[192:195]
    ds_read_b64_tr_b16 v[42:43], v241 offset:57344
    v_mfma_f32_16x16x32_bf16 v[196:199], v[96:99], v[12:15], v[196:199]
    ds_read_b64_tr_b16 v[120:121], v242 offset:56320
    v_mfma_f32_16x16x32_bf16 v[216:219], v[96:99], v[16:19], v[216:219]
    ds_read_b64_tr_b16 v[122:123], v242 offset:56576
    s_waitcnt vmcnt(2) lgkmcnt(10)
    v_mfma_f32_16x16x32_bf16 v[180:183], v[36:39], v[20:23], v[180:183]
    v_mfma_f32_16x16x32_bf16 v[200:203], v[36:39], v[24:27], v[200:203]
    v_mfma_f32_16x16x32_bf16 v[204:207], v[220:223], v[24:27], v[204:207]
    v_mfma_f32_16x16x32_bf16 v[184:187], v[220:223], v[20:23], v[184:187]
    v_mfma_f32_16x16x32_bf16 v[188:191], v[100:103], v[20:23], v[188:191]
    v_mfma_f32_16x16x32_bf16 v[208:211], v[100:103], v[24:27], v[208:211]
    v_mfma_f32_16x16x32_bf16 v[212:215], v[104:107], v[24:27], v[212:215]
    v_mfma_f32_16x16x32_bf16 v[192:195], v[104:107], v[20:23], v[192:195]
    v_mfma_f32_16x16x32_bf16 v[196:199], v[108:111], v[20:23], v[196:199]
    v_mfma_f32_16x16x32_bf16 v[216:219], v[108:111], v[24:27], v[216:219]
    s_cmp_eq_u32 s62, 0
    s_waitcnt vmcnt(0) lgkmcnt(0)
    s_cbranch_scc1 F_k0
    v_mfma_f32_16x16x32_bf16 v[180:183], v[112:115], v[28:31], v[180:183]
    v_mfma_f32_16x16x32_bf16 v[184:187], v[116:119], v[28:31], v[184:187]
    v_mfma_f32_16x16x32_bf16 v[188:191], v[224:227], v[28:31], v[188:191]
    v_mfma_f32_16x16x32_bf16 v[192:195], v[40:43], v[28:31], v[192:195]
    v_mfma_f32_16x16x32_bf16 v[196:199], v[120:123], v[28:31], v[196:199]
    v_mfma_f32_16x16x32_bf16 v[200:203], v[112:115], v[32:35], v[200:203]
    v_mfma_f32_16x16x32_bf16 v[204:207], v[116:119], v[32:35], v[204:207]
    v_mfma_f32_16x16x32_bf16 v[208:211], v[224:227], v[32:35], v[208:211]
    v_mfma_f32_16x16x32_bf16 v[212:215], v[40:43], v[32:35], v[212:215]
    ds_write_b128 v243, v[180:183] offset:0
    v_mfma_f32_16x16x32_bf16 v[216:219], v[120:123], v[32:35], v[216:219]
    ds_write_b128 v243, v[184:187] offset:1024
    ds_write_b128 v243, v[188:191] offset:2048
    ds_write_b128 v243, v[192:195] offset:3072
    ds_write_b128 v243, v[196:199] offset:4096
    s_waitcnt lgkmcnt(0)
    s_barrier
    ds_read_b128 v[124:127], v244 offset:0
    ds_read_b128 v[128:131], v244 offset:1024
    ds_read_b128 v[132:135], v244 offset:2048
    ds_read_b128 v[136:139], v244 offset:3072
    ds_read_b128 v[44:47], v244 offset:4096
    s_waitcnt lgkmcnt(4)
    v_pk_add_f32 v[124:125], v[124:125], v[200:201]
    v_pk_add_f32 v[126:127], v[126:127], v[202:203]
    v_cvt_pk_bf16_f32 v48, v124, v125
    v_cvt_pk_bf16_f32 v49, v126, v127
    s_waitcnt lgkmcnt(3)
    v_pk_add_f32 v[128:129], v[128:129], v[204:205]
    v_pk_add_f32 v[130:131], v[130:131], v[206:207]
    v_cvt_pk_bf16_f32 v50, v128, v129
    v_cvt_pk_bf16_f32 v51, v130, v131
    s_waitcnt lgkmcnt(2)
    v_pk_add_f32 v[132:133], v[132:133], v[208:209]
    v_pk_add_f32 v[134:135], v[134:135], v[210:211]
    v_cvt_pk_bf16_f32 v140, v132, v133
    v_cvt_pk_bf16_f32 v141, v134, v135
    s_waitcnt lgkmcnt(1)
    v_pk_add_f32 v[136:137], v[136:137], v[212:213]
    v_pk_add_f32 v[138:139], v[138:139], v[214:215]
    v_cvt_pk_bf16_f32 v142, v136, v137
    v_cvt_pk_bf16_f32 v143, v138, v139
    s_waitcnt lgkmcnt(0)
    v_pk_add_f32 v[44:45], v[44:45], v[216:217]
    v_pk_add_f32 v[46:47], v[46:47], v[218:219]
    v_cvt_pk_bf16_f32 v144, v44, v45
    v_cvt_pk_bf16_f32 v145, v46, v47
    s_branch F_k1
F_k0:
    v_mfma_f32_16x16x32_bf16 v[200:203], v[112:115], v[32:35], v[200:203]
    v_mfma_f32_16x16x32_bf16 v[204:207], v[116:119], v[32:35], v[204:207]
    v_mfma_f32_16x16x32_bf16 v[208:211], v[224:227], v[32:35], v[208:211]
    v_mfma_f32_16x16x32_bf16 v[212:215], v[40:43], v[32:35], v[212:215]
    v_mfma_f32_16x16x32_bf16 v[216:219], v[120:123], v[32:35], v[216:219]
    v_mfma_f32_16x16x32_bf16 v[180:183], v[112:115], v[28:31], v[180:183]
    v_mfma_f32_16x16x32_bf16 v[184:187], v[116:119], v[28:31], v[184:187]
    v_mfma_f32_16x16x32_bf16 v[188:191], v[224:227], v[28:31], v[188:191]
    v_mfma_f32_16x16x32_bf16 v[192:195], v[40:43], v[28:31], v[192:195]
pad_T_4:
    s_cbranch_execz T_ret
    ds_write_b128 v243, v[200:203] offset:0
    v_mfma_f32_16x16x32_bf16 v[196:199], v[120:123], v[28:31], v[196:199]
    ds_write_b128 v243, v[204:207] offset:1024
    ds_write_b128 v243, v[208:211] offset:2048
    ds_write_b128 v243, v[212:215] offset:3072
    ds_write_b128 v243, v[216:219] offset:4096
    s_waitcnt lgkmcnt(0)
    s_barrier
    ds_read_b128 v[124:127], v244 offset:0
    ds_read_b128 v[128:131], v244 offset:1024
    ds_read_b128 v[132:135], v244 offset:2048
    ds_read_b128 v[136:139], v244 offset:3072
    ds_read_b128 v[44:47], v244 offset:4096
    s_waitcnt lgkmcnt(4)
    v_pk_add_f32 v[124:125], v[124:125], v[180:181]
    v_pk_add_f32 v[126:127], v[126:127], v[182:183]
    v_cvt_pk_bf16_f32 v48, v124, v125
    v_cvt_pk_bf16_f32 v49, v126, v127
    s_waitcnt lgkmcnt(3)
    v_pk_add_f32 v[128:129], v[128:129], v[184:185]
    v_pk_add_f32 v[130:131], v[130:131], v[186:187]
    v_cvt_pk_bf16_f32 v50, v128, v129
    v_cvt_pk_bf16_f32 v51, v130, v131
    s_waitcnt lgkmcnt(2)
    v_pk_add_f32 v[132:133], v[132:133], v[188:189]
    v_pk_add_f32 v[134:135], v[134:135], v[190:191]
    v_cvt_pk_bf16_f32 v140, v132, v133
    v_cvt_pk_bf16_f32 v141, v134, v135
    s_waitcnt lgkmcnt(1)
    v_pk_add_f32 v[136:137], v[136:137], v[192:193]
    v_pk_add_f32 v[138:139], v[138:139], v[194:195]
    v_cvt_pk_bf16_f32 v142, v136, v137
    v_cvt_pk_bf16_f32 v143, v138, v139
    s_waitcnt lgkmcnt(0)
    v_pk_add_f32 v[44:45], v[44:45], v[196:197]
    v_pk_add_f32 v[46:47], v[46:47], v[198:199]
    v_cvt_pk_bf16_f32 v144, v44, v45
    v_cvt_pk_bf16_f32 v145, v46, v47
F_k1:
    ds_write_b64 v245, v[48:49] offset:0
    ds_write_b64 v245, v[50:51] offset:32
    ds_write_b64 v245, v[140:141] offset:64
    ds_write_b64 v245, v[142:143] offset:96
    ds_write_b64 v245, v[144:145] offset:128
    s_waitcnt lgkmcnt(0)
    ds_read_b128 v[148:151], v246
    ds_read_b128 v[152:155], v247
    ds_read_b128 v[156:159], v248
    s_waitcnt lgkmcnt(2)
    buffer_store_dwordx4 v[148:151], v249, s[36:39], 0 offen nt
    s_waitcnt lgkmcnt(1)
    buffer_store_dwordx4 v[152:155], v250, s[36:39], 0 offen nt
    s_waitcnt lgkmcnt(0)
    s_mov_b32 exec_hi, 0
    buffer_store_dwordx4 v[156:159], v251, s[36:39], 0 offen
    s_mov_b32 exec_hi, -1
    s_endpgm
    .p2align 6
F_helper:
    s_lshl_b32 s54, s52, 1
    s_add_u32 s54, s54, s53
    s_sub_u32 s54, s54, 30
    v_lshrrev_b32 v5, 1, v2
    v_mul_u32_u24 v5, 1280, v5
    v_and_b32 v6, 1, v2
    v_lshl_add_u32 v5, v6, 4, v5
    s_mul_i32 s56, s54, 122880
    s_lshl_b32 s57, s18, 5
    s_add_u32 s57, s57, s56
    s_add_u32 s57, s57, 1024
    v_add_u32 v11, s57, v5
    s_mul_i32 s57, s18, 49152
    s_mul_i32 s58, s54, 3072
    s_add_u32 s57, s57, s58
    s_add_u32 s57, s57, 1048576
    v_lshl_add_u32 v12, v2, 4, s57
    v_lshrrev_b32 v5, 3, v2
    v_mul_u32_u24 v5, 1280, v5
    v_and_b32 v6, 7, v2
    v_lshl_add_u32 v5, v6, 7, v5
    s_mul_i32 s57, s18, 30720
    s_add_u32 s57, s57, s56
    v_add_u32 v13, s57, v5
    v_mov_b32 v8, 0
    s_mov_b32 s55, 40960
    s_mov_b32 s56, 81920
    s_movk_i32 s58, 10240
    s_waitcnt lgkmcnt(0)
    s_mov_b32 s32, s10
    s_and_b32 s33, s11, 0xffff
    s_mov_b32 s34, 1966080
    s_mov_b32 s35, 0x00020000
    s_mov_b32 s40, s16
    s_and_b32 s41, s17, 0xffff
    s_mov_b32 s42, 268435456
    s_mov_b32 s43, 0x00020000
    s_mov_b32 s44, s14
    s_and_b32 s45, s15, 0xffff
    s_mov_b32 s46, 256
    s_mov_b32 s47, 0x00020000
    s_mov_b32 s36, s12
    s_and_b32 s37, s13, 0xffff
    s_mov_b32 s38, 2621440
    s_mov_b32 s39, 0x00020000
    buffer_load_dwordx4 v[64:67], v11, s[32:35], 0 offen
    buffer_load_dwordx4 v[68:71], v11, s[32:35], s55 offen
    buffer_load_dwordx4 v[72:75], v11, s[32:35], s56 offen
    s_waitcnt vmcnt(2)
    buffer_store_dwordx4 v[64:67], v12, s[40:43], 0 offen offset:0 sc1
    s_waitcnt vmcnt(2)
    buffer_store_dwordx4 v[68:71], v12, s[40:43], 0 offen offset:1024 sc1
    s_waitcnt vmcnt(2)
    buffer_store_dwordx4 v[72:75], v12, s[40:43], 0 offen offset:2048 sc1
    buffer_load_dwordx2 v[30:31], v8, s[44:47], 0 offen sc1
    s_waitcnt vmcnt(0)
    s_mov_b32 s70, 0
F_Hnonce:
    v_cmp_ne_u64 vcc, 0, v[30:31]
    s_add_u32 s70, s70, 1
    s_nop 3
    s_cbranch_vccnz F_Hnonce_ok
    s_cmp_gt_u32 s70, 262144
    s_cbranch_scc1 F_Hnonce_ok
    s_sleep 4
    buffer_load_dwordx2 v[30:31], v8, s[44:47], 0 offen sc1
    s_waitcnt vmcnt(0)
    s_branch F_Hnonce
F_Hnonce_ok:
    s_lshl_b32 s57, s54, 7
    s_add_u32 s57, s57, 0
    v_mov_b32 v28, s57
    s_barrier
    s_cmp_lg_u32 s18, 4
    s_cbranch_scc1 F_Hnf
    s_lshl_b32 s57, s54, 9
    s_add_u32 s57, s57, 0x10000
    v_mov_b32 v33, s57
    s_mov_b64 exec, 1
    s_movk_i32 s58, 0x2000
    s_mov_b32 s64, -1
    s_mov_b32 s65, -1
    s_memtime s[92:93]
    s_waitcnt lgkmcnt(0)
    buffer_store_dword v8, v33, s[40:43], 0 offen offset:0 sc1
    s_waitcnt vmcnt(0)
    s_memtime s[94:95]
    s_waitcnt lgkmcnt(0)
    s_sub_u32 s94, s94, s92
    s_min_u32 s64, s64, s94
    s_memtime s[92:93]
    s_waitcnt lgkmcnt(0)
    buffer_store_dword v8, v33, s[40:43], s58 offen offset:0 sc1
    s_waitcnt vmcnt(0)
    s_memtime s[94:95]
    s_waitcnt lgkmcnt(0)
    s_sub_u32 s94, s94, s92
    s_min_u32 s65, s65, s94
    s_cmp_gt_u32 s64, s65
    s_cselect_b32 s57, 1, 0
    s_lshr_b32 s58, s52, 2
    s_xor_b32 s57, s57, s58
    v_or_b32 v34, s57, v30
    v_mov_b32 v35, v31
    buffer_store_dwordx2 v[34:35], v28, s[40:43], 0 offen sc1
    s_mov_b64 exec, -1
F_Hnf:
    s_barrier
    s_cmp_lt_u32 s18, 4
    s_cbranch_scc1 F_HC
    s_sub_u32 s19, s18, 4
    s_lshr_b32 s57, s53, 2
    s_and_b32 s58, s53, 3
    s_lshr_b32 s59, s52, 2
    s_lshl_b32 s59, s59, 1
    s_and_b32 s60, s52, 1
    s_add_u32 s59, s59, s60
    s_lshl_b32 s59, s59, 3
    s_add_u32 s59, s59, s57
    s_bfe_u32 s60, s52, 0x10001
    s_lshl_b32 s60, s60, 2
    s_add_u32 s60, s60, s58
    s_mul_i32 s57, s57, 3
    s_mul_i32 s58, s58, 0
    s_add_u32 s61, s57, s58
    s_lshr_b32 s61, s61, 2
    s_mul_i32 s57, s61, 10923
    s_lshr_b32 s57, s57, 16
    s_mul_i32 s57, s57, 6
    s_sub_u32 s61, s61, s57
    v_and_b32 v5, 15, v2
    s_mov_b32 s57, 0
    v_mov_b32 v8, 0
    v_lshl_add_u32 v29, v5, 7, s57
    v_lshrrev_b32 v5, 3, v2
    v_mul_u32_u24 v5, 1280, v5
    v_lshrrev_b32 v6, 4, v2
    v_lshlrev_b32 v6, 1, v6
    v_and_b32 v7, 7, v2
    v_xor_b32 v6, v6, v7
    v_lshl_add_u32 v5, v6, 4, v5
    s_lshl_b32 s57, s60, 7
    v_add_u32 v20, s57, v5
    v_add_u32 v21, 9216, v20
    v_add_u32 v22, 18432, v20
    v_add_u32 v23, 27648, v20
    s_mul_i32 s57, s60, 49152
    s_add_u32 s57, s57, 1048576
    v_lshlrev_b32 v5, 4, v2
    v_add_u32 v24, s57, v5
    s_mul_i32 s71, s19, 5120
    v_add_u32 v25, s71, v5
    v_add_u32 v26, 40960, v25
    s_lshl_b32 s65, s61, 2
    s_add_u32 s65, s65, s19
    s_mul_i32 s78, s65, 40960
    s_lshl_b32 s84, s65, 10
    s_add_u32 s61, s61, 1
    s_cmp_eq_u32 s61, 6
    s_cselect_b32 s61, 0, s61
    s_lshl_b32 s65, s61, 2
    s_add_u32 s65, s65, s19
    s_mul_i32 s79, s65, 40960
    s_lshl_b32 s85, s65, 10
    s_add_u32 s61, s61, 1
    s_cmp_eq_u32 s61, 6
    s_cselect_b32 s61, 0, s61
    s_lshl_b32 s65, s61, 2
    s_add_u32 s65, s65, s19
    s_mul_i32 s80, s65, 40960
    s_lshl_b32 s86, s65, 10
    s_add_u32 s61, s61, 1
    s_cmp_eq_u32 s61, 6
    s_cselect_b32 s61, 0, s61
    s_lshl_b32 s65, s61, 2
    s_add_u32 s65, s65, s19
    s_mul_i32 s81, s65, 40960
    s_lshl_b32 s87, s65, 10
    s_add_u32 s61, s61, 1
    s_cmp_eq_u32 s61, 6
    s_cselect_b32 s61, 0, s61
    s_lshl_b32 s65, s61, 2
    s_add_u32 s65, s65, s19
    s_mul_i32 s82, s65, 40960
    s_lshl_b32 s88, s65, 10
    s_add_u32 s61, s61, 1
    s_cmp_eq_u32 s61, 6
    s_cselect_b32 s61, 0, s61
    s_lshl_b32 s65, s61, 2
    s_add_u32 s65, s65, s19
    s_mul_i32 s83, s65, 40960
    s_lshl_b32 s89, s65, 10
    s_add_u32 s61, s61, 1
    s_cmp_eq_u32 s61, 6
    s_cselect_b32 s61, 0, s61
    buffer_load_dwordx2 v[40:41], v29, s[40:43], 0 offen sc1
    s_waitcnt vmcnt(0)
    v_readfirstlane_b32 s94, v30
    s_nop 3
    s_mul_i32 s94, s94, 0x9e3779b1
    s_mul_hi_u32 s94, s94, 31
    s_add_u32 s94, s94, 1
    s_lshl_b32 s94, s94, 23
    s_setprio 3
    s_mov_b32 s70, 0
F_Hpoll:
    v_cmp_ne_u32 s[92:93], v40, v30
    v_and_b32 v40, -2, v40
    v_cmp_ne_u64 vcc, v[40:41], v[30:31]
    s_add_u32 s70, s70, 1
    s_bcnt1_i32_b64 s57, s[92:93]
    s_cmp_gt_u32 s57, 32
    s_cselect_b32 s57, 8192, 0
    s_nop 0
    s_cbranch_vccz F_Hpoll_ok
    s_cmp_gt_u32 s70, 262144
    s_cbranch_scc1 F_Hpoll_ok
    s_sleep 4
    buffer_load_dwordx2 v[40:41], v29, s[40:43], 0 offen sc1
    s_waitcnt vmcnt(0)
    s_branch F_Hpoll
F_Hpoll_ok:
    s_or_b32 s57, s57, s94
    v_mov_b32 v32, s57
    s_setprio 0
    v_mov_b32 v5, 81920
    ds_write_b32 v5, v32
    s_waitcnt lgkmcnt(0)
    s_branch F_L2
F_HC:
    v_mov_b32 v18, v30
    v_mov_b32 v19, v31
    s_and_b32 s62, s18, 1
    s_lshr_b32 s63, s18, 1
    v_and_b32 v3, 15, v2
    v_lshrrev_b32 v4, 4, v2
    s_barrier
    v_mov_b32 v5, 81920
    ds_read_b32 v221, v5
    s_waitcnt lgkmcnt(0)
    s_barrier
    s_lshr_b32 s57, s53, 2
    s_and_b32 s58, s53, 3
    s_lshr_b32 s59, s52, 2
    s_lshl_b32 s59, s59, 1
    s_and_b32 s60, s52, 1
    s_add_u32 s59, s59, s60
    s_lshl_b32 s59, s59, 3
    s_add_u32 s59, s59, s57
    s_bfe_u32 s60, s52, 0x10001
    s_lshl_b32 s60, s60, 2
    s_add_u32 s60, s60, s58
    s_mul_i32 s57, s57, 3
    s_mul_i32 s58, s58, 0
    s_add_u32 s61, s57, s58
    s_lshr_b32 s61, s61, 2
    s_mul_i32 s57, s61, 10923
    s_lshr_b32 s57, s57, 16
    s_mul_i32 s57, s57, 6
    s_sub_u32 s61, s61, s57
    v_min_u32 v5, 47, v2
    s_lshl_b32 s64, s59, 2
    s_add_u32 s64, s64, 0
    s_cmp_ge_u32 s64, 116
    s_addc_u32 s64, s64, 0
    s_mul_i32 s64, s64, 5042
    s_lshr_b32 s64, s64, 16
    s_cmp_ge_u32 s64, 5
    s_cselect_b32 s57, 5, 0
    s_cselect_b32 s58, 0, 8192
    s_sub_u32 s65, s64, s57
    s_lshl_b32 s65, s65, 1
    s_add_u32 s65, s65, s62
    s_lshr_b32 s57, s65, 2
    s_lshl_b32 s57, s57, 14
    s_add_u32 s58, s58, s57
    s_and_b32 s65, s65, 3
    s_lshl_b32 s65, s65, 11
    s_add_u32 s65, s65, s58
    s_add_u32 s65, s65, 6422528
    v_lshl_add_u32 v252, v5, 5, s65
    s_lshl_b32 s64, s59, 2
    s_add_u32 s64, s64, 3
    s_cmp_ge_u32 s64, 116
    s_addc_u32 s64, s64, 0
    s_mul_i32 s64, s64, 5042
    s_lshr_b32 s64, s64, 16
    s_cmp_ge_u32 s64, 5
    s_cselect_b32 s57, 5, 0
    s_cselect_b32 s58, 0, 8192
    s_sub_u32 s65, s64, s57
    s_lshl_b32 s65, s65, 1
    s_add_u32 s65, s65, s62
    s_lshr_b32 s57, s65, 2
    s_lshl_b32 s57, s57, 14
    s_add_u32 s58, s58, s57
    s_and_b32 s65, s65, 3
    s_lshl_b32 s65, s65, 11
    s_add_u32 s65, s65, s58
    s_add_u32 s65, s65, 6422528
    v_lshl_add_u32 v253, v5, 5, s65
    v_lshrrev_b32 v5, 1, v4
    v_lshlrev_b32 v5, 4, v5
    v_and_b32 v6, 1, v4
    v_lshl_add_u32 v5, v6, 2, v5
    v_lshrrev_b32 v6, 2, v3
    v_add_u32 v5, v5, v6
    v_and_b32 v6, 3, v3
    v_lshlrev_b32 v6, 3, v6
    s_mul_i32 s64, s62, 20480
    v_add_u32 v6, s64, v6
    v_lshl_add_u32 v7, v5, 5, v6
    v_add_u32 v242, 4096, v7
    v_lshl_add_u32 v6, v5, 7, v6
    v_bfe_u32 v5, v5, 1, 2
    v_xor_b32 v7, 0, v5
    v_lshl_add_u32 v238, v7, 5, v6
    v_xor_b32 v7, 1, v5
    v_lshl_add_u32 v239, v7, 5, v6
    v_xor_b32 v7, 2, v5
    v_lshl_add_u32 v240, v7, 5, v6
    v_xor_b32 v7, 3, v5
    v_lshl_add_u32 v241, v7, 5, v6
    s_lshl_b32 s64, s59, 2
    s_lshl_b32 s65, s63, 1
    s_add_u32 s64, s64, s65
    s_add_u32 s65, s64, 1
    s_lshr_b32 s57, s64, 6
    s_and_b32 s64, s64, 63
    s_mul_i32 s58, s64, 3121
    s_lshr_b32 s58, s58, 16
    s_xor_b32 s57, s57, s58
    s_and_b32 s57, s57, 1
    s_lshl_b32 s57, s57, 13
    s_mul_i32 s58, s58, 32768
    s_mul_i32 s64, s64, 98304
    s_add_u32 s64, s64, s58
    s_add_u32 s64, s64, s57
    s_lshr_b32 s57, s65, 6
    s_and_b32 s65, s65, 63
    s_mul_i32 s58, s65, 3121
    s_lshr_b32 s58, s58, 16
    s_xor_b32 s57, s57, s58
    s_and_b32 s57, s57, 1
    s_lshl_b32 s57, s57, 13
    s_mul_i32 s58, s58, 32768
    s_mul_i32 s65, s65, 98304
    s_add_u32 s65, s65, s58
    s_add_u32 s65, s65, s57
    v_lshl_add_u32 v236, v2, 4, s64
    v_lshl_add_u32 v237, v2, 4, s65
    s_mul_i32 s64, s62, 6
    s_add_u32 s64, s64, s61
    s_lshr_b32 s65, s64, 1
    s_lshl_b32 s65, s65, 14
    s_and_b32 s64, s64, 1
    s_lshl_b32 s64, s64, 12
    s_add_u32 s96, s64, s65
    s_add_u32 s61, s61, 1
    s_cmp_eq_u32 s61, 6
    s_cselect_b32 s61, 0, s61
    s_mul_i32 s64, s62, 6
    s_add_u32 s64, s64, s61
    s_lshr_b32 s65, s64, 1
    s_lshl_b32 s65, s65, 14
    s_and_b32 s64, s64, 1
    s_lshl_b32 s64, s64, 12
    s_add_u32 s97, s64, s65
    s_add_u32 s61, s61, 1
    s_cmp_eq_u32 s61, 6
    s_cselect_b32 s61, 0, s61
    s_mul_i32 s64, s62, 6
    s_add_u32 s64, s64, s61
    s_lshr_b32 s65, s64, 1
    s_lshl_b32 s65, s65, 14
    s_and_b32 s64, s64, 1
    s_lshl_b32 s64, s64, 12
    s_add_u32 s98, s64, s65
    s_add_u32 s61, s61, 1
    s_cmp_eq_u32 s61, 6
    s_cselect_b32 s61, 0, s61
    s_mul_i32 s64, s62, 6
    s_add_u32 s64, s64, s61
    s_lshr_b32 s65, s64, 1
    s_lshl_b32 s65, s65, 14
    s_and_b32 s64, s64, 1
    s_lshl_b32 s64, s64, 12
    s_add_u32 s99, s64, s65
    s_add_u32 s61, s61, 1
    s_cmp_eq_u32 s61, 6
    s_cselect_b32 s61, 0, s61
    s_mul_i32 s64, s62, 6
    s_add_u32 s64, s64, s61
    s_lshr_b32 s65, s64, 1
    s_lshl_b32 s65, s65, 14
    s_and_b32 s64, s64, 1
    s_lshl_b32 s64, s64, 12
    s_add_u32 s100, s64, s65
    s_add_u32 s61, s61, 1
    s_cmp_eq_u32 s61, 6
    s_cselect_b32 s61, 0, s61
    s_mul_i32 s64, s62, 6
    s_add_u32 s64, s64, s61
    s_lshr_b32 s65, s64, 1
    s_lshl_b32 s65, s65, 14
    s_and_b32 s64, s64, 1
    s_lshl_b32 s64, s64, 12
    s_add_u32 s101, s64, s65
    s_add_u32 s61, s61, 1
    s_cmp_eq_u32 s61, 6
    s_cselect_b32 s61, 0, s61
    s_mul_i32 s64, s18, 5120
    s_add_u32 s64, s64, 81920
    v_lshl_add_u32 v243, v2, 4, s64
    s_xor_b32 s65, s18, 1
    s_mul_i32 s65, s65, 5120
    s_add_u32 s65, s65, 81920
    v_lshl_add_u32 v244, v2, 4, s65
    v_xor_b32 v252, v252, v221
    v_xor_b32 v253, v253, v221
    v_xor_b32 v236, v236, v221
    v_xor_b32 v237, v237, v221
    s_mul_i32 s64, s18, 2816
    s_add_u32 s64, s64, 122880
    v_mul_u32_u24 v5, 176, v3
    v_lshlrev_b32 v6, 3, v4
    v_add3_u32 v245, v5, v6, s64
    s_lshl_b32 s65, s59, 6
    s_lshl_b32 s57, s63, 5
    s_add_u32 s65, s65, s57
    s_lshl_b32 s57, s62, 4
    s_add_u32 s65, s65, s57
    s_mul_i32 s65, s65, 1280
    s_lshl_b32 s57, s60, 7
    s_add_u32 s65, s65, s57
    v_lshrrev_b32 v6, 3, v2
    v_and_b32 v7, 7, v2
    v_lshlrev_b32 v7, 4, v7
    v_mul_u32_u24 v5, 176, v6
    v_add3_u32 v246, v5, v7, s64
    v_mul_u32_u24 v5, 1280, v6
    v_add3_u32 v249, v5, v7, s65
    v_add_u32 v247, 1408, v246
    v_add_u32 v250, 10240, v249
    s_mul_i32 s57, s60, 96
    s_sub_u32 s65, s65, s57
    s_add_u32 s65, s65, 1024
    s_add_u32 s64, s64, 128
    v_lshrrev_b32 v6, 1, v2
    v_and_b32 v6, 15, v6
    v_and_b32 v7, 1, v2
    v_lshlrev_b32 v7, 4, v7
    v_mul_u32_u24 v5, 176, v6
    v_add3_u32 v248, v5, v7, s64
    v_mul_u32_u24 v5, 1280, v6
    v_add3_u32 v251, v5, v7, s65
    s_lshl_b32 s57, s54, 7
    s_add_u32 s57, s57, 4096
    v_mov_b32 v9, s57
    s_branch F_C2b
.section .rodata,"a"
.p2align 6
.amdhsa_kernel standalone__glu_gated_geglu__prompt_kernel
  .amdhsa_next_free_vgpr 256
  .amdhsa_next_free_sgpr 102
  .amdhsa_accum_offset 256
  .amdhsa_group_segment_fixed_size 0
  .amdhsa_kernarg_size 56
  .amdhsa_user_sgpr_count 2
  .amdhsa_user_sgpr_kernarg_segment_ptr 1
  .amdhsa_system_sgpr_workgroup_id_x 1
  .amdhsa_float_denorm_mode_32 3
.end_amdhsa_kernel
```
